```python
import torch

def _softmax(x, axis=-1):
    return torch.softmax(x, dim=axis)
def _gelu(x):
    return torch.nn.functional.gelu(x, approximate="tanh")
def _silu(x):
    return torch.nn.functional.silu(x)
def _sigmoid(x):
    return torch.sigmoid(x)
def _layernorm(x, axis=-1, eps=1e-5):
    m = x.mean(dim=axis, keepdim=True)
    v = x.var(dim=axis, keepdim=True, unbiased=False)
    return (x - m) / torch.sqrt(v + eps)
def _scatter_add(tgt, idx, src, axis=0):
    return tgt.clone().index_add_(axis, idx, src)
def _segment_sum(src, seg, n):
    out = torch.zeros((n,) + src.shape[1:], dtype=src.dtype)
    return out.index_add_(0, seg, src)
def _pad(x, pw):
    flat = tuple(v for pair in reversed(pw) for v in pair)
    return torch.nn.functional.pad(x, flat)

kernel_name = 'gated_mix__spectral_gfnet__ssm_conv_s5__prompt'

def setup_inputs():

    _w = (lambda a: (lambda t: t.to(torch.bfloat16) if t.is_floating_point() else t)(torch.as_tensor(a)))
    def _A_setup():
        B, S, D = 1, 2048, 640
        Df = D // 2 + 1
        return {
            "x": _w((lambda *s: torch.randn(*s, dtype=torch.bfloat16) * 0.05)(B, S, D)),
            "w_r": _w((lambda *s: torch.randn(*s, dtype=torch.bfloat16) * 0.8)(S, Df) * 0.02),
            "w_i": _w((lambda *s: torch.randn(*s, dtype=torch.bfloat16) * 0.8)(S, Df) * 0.02),
        }
    _A_in = _A_setup()

    def _B_setup():
        B, S, D = 1, 2048, 640
        P = D
        Lambda_re = -0.5 * (lambda _x: torch.exp(torch.as_tensor(_x)))((lambda *s: torch.randn(*s, dtype=torch.bfloat16) * 0.2)(P))
        Lambda_im = (lambda *s: torch.randn(*s, dtype=torch.bfloat16) * 0.2)(P) * 1.0
        B_re = (lambda *s: torch.randn(*s, dtype=torch.bfloat16) * 0.2)(P, D) * (D ** -0.5)
        B_im = (lambda *s: torch.randn(*s, dtype=torch.bfloat16) * 0.2)(P, D) * (D ** -0.5)
        C_re = (lambda *s: torch.randn(*s, dtype=torch.bfloat16) * 0.2)(D, P) * (P ** -0.5)
        C_im = (lambda *s: torch.randn(*s, dtype=torch.bfloat16) * 0.2)(D, P) * (P ** -0.5)
        log_dt = (lambda *s: torch.randn(*s, dtype=torch.bfloat16) * 0.2)(P) * 0.3 - 2.0
        Dskip = (lambda *s: torch.randn(*s, dtype=torch.bfloat16) * 0.05)(D)
        return {
            "x": _w((lambda *s: torch.randn(*s, dtype=torch.bfloat16) * 0.05)(B, S, D)),
            "Lambda_re": _w(Lambda_re),
            "Lambda_im": _w(Lambda_im),
            "B_re": _w(B_re),
            "B_im": _w(B_im),
            "C_re": _w(C_re),
            "C_im": _w(C_im),
            "log_dt": _w(log_dt),
            "Dskip": _w(Dskip),
        }
    _B_in = _B_setup()

    return {
        "A_x": _A_in["x"],
        "A_w_r": _A_in["w_r"],
        "A_w_i": _A_in["w_i"],
        "B_x": _B_in["x"],
        "B_Lambda_re": _B_in["Lambda_re"],
        "B_Lambda_im": _B_in["Lambda_im"],
        "B_B_re": _B_in["B_re"],
        "B_B_im": _B_in["B_im"],
        "B_C_re": _B_in["C_re"],
        "B_C_im": _B_in["C_im"],
        "B_log_dt": _B_in["log_dt"],
        "B_Dskip": _B_in["Dskip"],
        "gate_w": _w((lambda *s: torch.randn(*s, dtype=torch.bfloat16) * 0.05)(640) * 16.0),
    }

def reference(A_x, A_w_r, A_w_i, B_x, B_Lambda_re, B_Lambda_im, B_B_re, B_B_im, B_C_re, B_C_im, B_log_dt, B_Dskip, gate_w):
    def _A_ref(x, w_r, w_i):
        B, S, D = x.shape
        X = (lambda x, axes=(-2,-1): torch.fft.rfft2(x.float(), dim=axes))(x, axes=(-2, -1))
        W = w_r + 1j * w_i
        X = X * W
        y = (lambda x, s, axes=(-2,-1): torch.fft.irfft2(x, s=s, dim=axes).to(torch.bfloat16))(X, (S, D), axes=(-2, -1))
        return y

    def _B_ref(x, Lambda_re, Lambda_im, B_re, B_im, C_re, C_im, log_dt, Dskip):
        Bsz, L, H = x.shape
        Lam = Lambda_re + 1j * Lambda_im
        Bmat = B_re + 1j * B_im
        Cmat = C_re + 1j * C_im
        dt = torch.exp(log_dt)
        Lam_bar = torch.exp(dt * Lam)
        B_bar = ((Lam_bar - 1.0) / Lam)[:, None] * Bmat
        Bu = torch.einsum("bld,pd->blp", x + 0j, B_bar)
        h = torch.zeros_like(Bu[:, 0, :])
        hs = []
        for t in range(L):
            h = Lam_bar[None, :] * h + Bu[:, t, :]
            hs.append(h)
        hseq = torch.stack(hs, 1)
        y = 2.0 * torch.einsum("blp,dp->bld", hseq, Cmat).real + x * Dskip[None, None, :]
        return y

    x = A_x
    g = _sigmoid((x * gate_w).sum(-1, keepdims=True))
    a = _A_ref(x, A_w_r, A_w_i)
    b = _B_ref(x, B_Lambda_re, B_Lambda_im, B_B_re, B_B_im, B_C_re, B_C_im, B_log_dt, B_Dskip)
    return g * a + (1 - g) * b
```

```asm
; @launch grid=(256,1,1) block=(512,1,1) lds=163840
.amdgcn_target "amdgcn-amd-amdhsa--gfx950"
.text
.globl gated_mix__spectral_gfnet__ssm_conv_s5__prompt_kernel
.p2align 8
.type gated_mix__spectral_gfnet__ssm_conv_s5__prompt_kernel,@function
gated_mix__spectral_gfnet__ssm_conv_s5__prompt_kernel:
    s_cmp_ge_u32 s2, 256
    s_cbranch_scc1 W_END
    s_load_dwordx16 s[36:51], s[0:1], 0
    s_load_dwordx16 s[52:67], s[0:1], 64
    v_lshrrev_b32 v4, 6, v0
    v_and_b32 v1, 63, v0
    v_readfirstlane_b32 s3, v4
    v_lshrrev_b32 v2, 4, v1
    v_and_b32 v3, 15, v1
    v_lshlrev_b32 v6, 4, v1
    v_and_b32 v7, 31, v1
    v_lshrrev_b32 v8, 5, v1
    v_lshlrev_b32 v9, 2, v4
    v_add_u32 v9, 162304, v9
    v_mov_b32 v11, 162304
    v_mov_b32 v10, 0
    v_mov_b32 v5, 0
    ds_write_b32 v9, v5
    v_and_b32 v0, 255, v0
    s_and_b32 s24, s3, 3
    s_lshr_b32 s35, s2, 3
    s_lshr_b32 s90, s2, 6
    s_and_b32 s28, s35, 7
    s_bfe_u32 s25, s2, 0x20001
    s_lshl_b32 s25, s25, 2
    s_add_u32 s25, s25, s90
    s_and_b32 s26, s2, 1
    s_lshl_b32 s26, s26, 3
    s_add_u32 s26, s26, s28
    s_and_b32 s27, s2, 7
    s_lshl_b32 s27, s27, 2
    s_add_u32 s27, s27, s90
    s_mov_b32 s78, 0x3e9e377a
    s_mov_b32 s79, 0x3e9e377a
    s_mov_b32 s80, 0xbf4f1bbd
    s_mov_b32 s81, 0xbf4f1bbd
    s_mov_b32 s82, 0x3f737871
    s_mov_b32 s83, 0x3f737871
    s_mov_b32 s84, 0x3f167918
    s_mov_b32 s85, 0x3f167918
    s_cmp_ge_u32 s3, 4
    s_cbranch_scc1 W_F
    s_lshr_b32 s90, s2, 6
    s_add_u32 s33, s90, s28
    s_cmp_ge_u32 s33, 5
    s_cselect_b32 s34, 5, 0
    s_sub_u32 s33, s33, s34
    s_cmp_ge_u32 s33, 5
    s_cselect_b32 s34, 5, 0
    s_sub_u32 s33, s33, s34
    s_lshl_b32 s68, s33, 8
    s_add_u32 s69, s68, 256
    s_cmp_ge_u32 s69, 1280
    s_cselect_b32 s69, 0, s69
    s_add_u32 s70, s69, 256
    s_cmp_ge_u32 s70, 1280
    s_cselect_b32 s70, 0, s70
    s_add_u32 s71, s70, 256
    s_cmp_ge_u32 s71, 1280
    s_cselect_b32 s71, 0, s71
    s_add_u32 s72, s71, 256
    s_cmp_ge_u32 s72, 1280
    s_cselect_b32 s72, 0, s72
    s_lshr_b32 s91, s24, 1
    s_and_b32 s92, s24, 1
    s_lshl_b32 s73, s25, 2
    s_add_u32 s73, s73, s24
    s_mul_i32 s73, s73, 40960
    s_mul_i32 s74, s26, 51200
    s_lshl_b32 s33, s91, 7
    s_add_u32 s74, s74, s33
    s_mul_i32 s76, s91, 10240
    s_mul_i32 s33, s92, 5120
    s_add_u32 s76, s76, s33
    s_mul_i32 s75, s24, 12288
    s_add_u32 s75, s75, 81920
    v_bfe_u32 v4, v1, 3, 2
    v_lshl_add_u32 v4, v8, 3, v4
    v_mul_u32_u24 v4, 1280, v4
    v_and_b32 v5, 7, v1
    v_xor_b32 v5, v5, v2
    v_lshl_add_u32 v100, v5, 4, v4
    v_xor_b32 v101, 64, v100
    v_add_u32 v102, 3072, v100
    v_add_u32 v103, 22528, v101
    v_add_u32 v101, 19456, v101
    v_lshrrev_b32 v4, 3, v1
    v_and_b32 v5, 6, v4
    v_xor_b32 v5, v5, v1
    v_xor_b32 v5, s92, v5
    v_and_b32 v5, 7, v5
    v_mul_u32_u24 v4, 1280, v4
    v_lshl_add_u32 v104, v5, 4, v4
    v_add_u32 v105, 9216, v104
    v_add_u32 v106, 18432, v104
    v_add_u32 v107, 27648, v104
    v_add_u32 v108, 40960, v104
    v_lshrrev_b32 v168, 2, v0
    v_min_u32 v168, 39, v168
    s_mul_i32 s33, s26, 40
    v_add_lshl_u32 v168, s33, v168, 1
    s_waitcnt lgkmcnt(0)
    s_mov_b32 s42, s3
    s_mov_b32 s8, s36
    s_mov_b32 s9, s37
    s_mov_b32 s10, 2621440
    s_mov_b32 s11, 0x20000
    s_cmp_eq_u32 s92, 0
    s_cselect_b32 s12, s48, s50
    s_cselect_b32 s13, s49, s51
    s_mov_b32 s14, 819200
    s_mov_b32 s15, 0x20000
    s_barrier
    global_load_ushort v170, v168, s[44:45]
    global_load_ushort v171, v168, s[46:47]
    global_load_ushort v172, v168, s[56:57]
    s_add_u32 m0, s76, 0
    s_add_u32 s91, s74, s68
    buffer_load_dwordx4 v104, s[12:15], s91 offen lds
    buffer_load_dwordx4 v105, s[12:15], s91 offen offset:1024 lds
    buffer_load_dwordx4 v106, s[12:15], s91 offen offset:2048 lds
    buffer_load_dwordx4 v107, s[12:15], s91 offen offset:3072 lds
    s_add_u32 m0, s76, 4096
    s_nop 0
    buffer_load_dwordx4 v108, s[12:15], s91 offen lds
    s_add_u32 m0, s75, 0
    s_add_u32 s90, s73, s68
    buffer_load_dwordx4 v100, s[8:11], s90 offen lds
    buffer_load_dwordx4 v101, s[8:11], s90 offen offset:1024 lds
    buffer_load_dwordx4 v102, s[8:11], s90 offen offset:2048 lds
    buffer_load_dwordx4 v103, s[8:11], s90 offen offset:3072 lds
    s_add_u32 m0, s76, 20480
    s_add_u32 s91, s74, s69
    buffer_load_dwordx4 v104, s[12:15], s91 offen lds
    buffer_load_dwordx4 v105, s[12:15], s91 offen offset:1024 lds
    buffer_load_dwordx4 v106, s[12:15], s91 offen offset:2048 lds
    buffer_load_dwordx4 v107, s[12:15], s91 offen offset:3072 lds
    s_add_u32 m0, s76, 24576
    s_nop 0
    buffer_load_dwordx4 v108, s[12:15], s91 offen lds
    s_mov_b32 s4, s66
    s_mov_b32 s5, s67
    s_mov_b32 s6, 268435456
    s_mov_b32 s7, 0x20000
    v_lshrrev_b32 v4, 1, v3
    v_and_b32 v5, 1, v3
    v_and_b32 v109, 6, v4
    v_xor_b32 v109, v109, v5
    v_xor_b32 v109, v109, v2
    v_lshlrev_b32 v109, 4, v109
    v_lshl_add_u32 v109, v4, 7, v109
    v_mul_u32_u24 v5, 5120, v5
    v_add_u32 v109, v109, v5
    v_xor_b32 v110, 64, v109
    v_xor_b32 v111, v4, v2
    v_lshlrev_b32 v111, 4, v111
    v_lshl_add_u32 v111, v3, 7, v111
    v_add_u32 v111, s75, v111
    v_xor_b32 v112, 64, v111
    v_lshrrev_b32 v4, 2, v0
    v_lshlrev_b32 v12, 4, v4
    v_cmp_gt_u32 vcc, 40, v4
    v_and_b32 v5, 3, v0
    v_cmp_eq_u32 s[86:87], 3, v5
    s_nop 0
    s_and_b64 vcc, vcc, s[86:87]
    v_mov_b32 v13, 1073741824
    v_cndmask_b32 v12, v13, v12, vcc
    s_lshl_b32 s92, s26, 4
    s_add_u32 s92, s92, s25
    s_mul_i32 s93, s92, 640
    s_add_u32 s93, s93, 12165120
    v_mul_u32_u24 v13, 1344, v5
    v_min_u32 v4, 39, v4
    v_lshl_add_u32 v13, v4, 3, v13
    v_add_u32 v13, 40960, v13
    v_lshrrev_b32 v4, 3, v0
    s_mov_b32 s33, 163840
    v_and_b32 v14, 7, v1
    v_lshlrev_b32 v14, 4, v14
    v_mad_u32_u24 v14, v4, s33, v14
    s_mul_i32 s88, s25, 10240
    s_mul_i32 s33, s26, 640
    s_add_u32 s88, s88, s33
    s_add_u32 s88, s88, 8192
    s_lshl_b32 s33, s24, 2
    v_add_u32 v230, s33, v2
    v_mul_u32_u24 v230, 336, v230
    v_lshl_add_u32 v230, v3, 2, v230
    v_add_u32 v230, 40960, v230
    s_waitcnt vmcnt(14)
    v_lshlrev_b32 v170, 16, v170
    v_lshlrev_b32 v171, 16, v171
    v_lshlrev_b32 v172, 16, v172
    v_mul_f32 v188, 0x3fb8aa3b, v172
    v_exp_f32 v188, v188
    s_nop 0
    v_cvt_pk_bf16_f32 v188, v188, v188
    v_and_b32 v188, 0xffff0000, v188
    v_mul_f32 v166, v188, v170
    v_mul_f32 v167, v188, v171
    v_mul_f32 v166, 0x3fb8aa3b, v166
    v_mul_f32 v167, 0x3e22f983, v167
    v_fract_f32 v188, v167
    v_exp_f32 v189, v166
    v_cos_f32 v192, v188
    v_sin_f32 v193, v188
    v_mul_f32 v192, v192, v189
    v_mul_f32 v193, v193, v189
    v_lshrrev_b32 v190, 2, v0
    v_lshlrev_b32 v190, 3, v190
    v_add_u32 v190, 161792, v190
    ds_write_b64 v190, v[192:193]
    v_mul_f32 v190, 0x41000000, v166
    v_mul_f32 v191, 0x41000000, v167
    v_fract_f32 v188, v191
    v_exp_f32 v189, v190
    v_cos_f32 v196, v188
    v_sin_f32 v197, v188
    v_mul_f32 v196, v196, v189
    v_mul_f32 v197, v197, v189
    v_mul_f32 v190, 0x42000000, v166
    v_mul_f32 v191, 0x42000000, v167
    v_fract_f32 v188, v191
    v_exp_f32 v189, v190
    v_cos_f32 v226, v188
    v_sin_f32 v227, v188
    v_mul_f32 v226, v226, v189
    v_mul_f32 v227, v227, v189
    v_mul_f32 v190, 0x42800000, v166
    v_mul_f32 v191, 0x42800000, v167
    v_fract_f32 v188, v191
    v_exp_f32 v189, v190
    v_cos_f32 v228, v188
    v_sin_f32 v229, v188
    v_mul_f32 v228, v228, v189
    v_mul_f32 v229, v229, v189
    s_add_u32 m0, s75, 4096
    s_add_u32 s90, s73, s68
    s_add_u32 s90, s90, 128
    buffer_load_dwordx4 v100, s[8:11], s90 offen lds
    buffer_load_dwordx4 v101, s[8:11], s90 offen offset:1024 lds
    buffer_load_dwordx4 v102, s[8:11], s90 offen offset:2048 lds
    buffer_load_dwordx4 v103, s[8:11], s90 offen offset:3072 lds
    s_add_u32 m0, s75, 8192
    s_add_u32 s90, s73, s69
    buffer_load_dwordx4 v100, s[8:11], s90 offen lds
    buffer_load_dwordx4 v101, s[8:11], s90 offen offset:1024 lds
    buffer_load_dwordx4 v102, s[8:11], s90 offen offset:2048 lds
    buffer_load_dwordx4 v103, s[8:11], s90 offen offset:3072 lds
    s_waitcnt vmcnt(13) lgkmcnt(0)
    v_mov_b32 v232, 1
    ds_write_b32 v9, v232
    ds_read_b128 v[232:235], v11 offset:0
    s_waitcnt lgkmcnt(0)
    s_mov_b32 s89, 0
    s_nop 0
G_W0_L:
    v_min3_u32 v232, v232, v233, v234
    v_min_u32 v232, v232, v235
    v_cmp_gt_u32 vcc, 1, v232
    s_nop 3
    s_cbranch_vccz G_W0_D
    s_add_u32 s89, s89, 1
    s_cmp_ge_u32 s89, 320000
    s_cbranch_scc1 G_W0_D
    ds_read_b128 v[232:235], v11 offset:0
    s_waitcnt lgkmcnt(0)
    s_branch G_W0_L
    s_nop 0
G_W0_D:
    ds_read_b128 v[16:19], v111 offset:0
    ds_read_b128 v[20:23], v111 offset:2048
    ds_read_b128 v[24:27], v109 offset:0
    ds_read_b128 v[28:31], v109 offset:1024
    ds_read_b128 v[32:35], v109 offset:2048
    ds_read_b128 v[36:39], v109 offset:3072
    ds_read_b128 v[40:43], v109 offset:4096
    ds_read_b128 v[44:47], v112 offset:0
    ds_read_b128 v[48:51], v112 offset:2048
    s_waitcnt lgkmcnt(2)
    v_mfma_f32_16x16x32_bf16 v[116:119], v[16:19], v[24:27], 0
    ds_read_b128 v[52:55], v110 offset:0
    s_add_u32 m0, s76, 40960
    s_add_u32 s91, s74, s70
    buffer_load_dwordx4 v104, s[12:15], s91 offen lds
    v_mfma_f32_16x16x32_bf16 v[120:123], v[20:23], v[24:27], 0
    ds_read_b128 v[56:59], v110 offset:1024
    buffer_load_dwordx4 v105, s[12:15], s91 offen offset:1024 lds
    v_mfma_f32_16x16x32_bf16 v[124:127], v[16:19], v[28:31], 0
    ds_read_b128 v[60:63], v110 offset:2048
    buffer_load_dwordx4 v106, s[12:15], s91 offen offset:2048 lds
    v_mfma_f32_16x16x32_bf16 v[128:131], v[20:23], v[28:31], 0
    ds_read_b128 v[64:67], v110 offset:3072
    buffer_load_dwordx4 v107, s[12:15], s91 offen offset:3072 lds
    v_mfma_f32_16x16x32_bf16 v[132:135], v[16:19], v[32:35], 0
    ds_read_b128 v[68:71], v110 offset:4096
    s_add_u32 m0, s76, 45056
    s_nop 0
    buffer_load_dwordx4 v108, s[12:15], s91 offen lds
    v_mfma_f32_16x16x32_bf16 v[136:139], v[20:23], v[32:35], 0
    s_waitcnt lgkmcnt(5)
    s_add_u32 m0, s75, 0
    s_add_u32 s90, s73, s69
    s_add_u32 s90, s90, 128
    buffer_load_dwordx4 v100, s[8:11], s90 offen lds
    v_mfma_f32_16x16x32_bf16 v[140:143], v[16:19], v[36:39], 0
    buffer_load_dwordx4 v101, s[8:11], s90 offen offset:1024 lds
    v_mfma_f32_16x16x32_bf16 v[144:147], v[20:23], v[36:39], 0
    buffer_load_dwordx4 v102, s[8:11], s90 offen offset:2048 lds
    v_mfma_f32_16x16x32_bf16 v[148:151], v[16:19], v[40:43], 0
    buffer_load_dwordx4 v103, s[8:11], s90 offen offset:3072 lds
    v_mfma_f32_16x16x32_bf16 v[152:155], v[20:23], v[40:43], 0
    s_waitcnt vmcnt(13) lgkmcnt(0)
    v_mfma_f32_16x16x32_bf16 v[116:119], v[44:47], v[52:55], v[116:119]
    ds_read_b128 v[16:19], v111 offset:4096
    v_mfma_f32_16x16x32_bf16 v[120:123], v[48:51], v[52:55], v[120:123]
    ds_read_b128 v[20:23], v111 offset:6144
    v_mfma_f32_16x16x32_bf16 v[124:127], v[44:47], v[56:59], v[124:127]
    ds_read_b128 v[24:27], v109 offset:10240
    v_mfma_f32_16x16x32_bf16 v[128:131], v[48:51], v[56:59], v[128:131]
    ds_read_b128 v[28:31], v109 offset:11264
    v_mfma_f32_16x16x32_bf16 v[132:135], v[44:47], v[60:63], v[132:135]
    ds_read_b128 v[32:35], v109 offset:12288
    v_mfma_f32_16x16x32_bf16 v[136:139], v[48:51], v[60:63], v[136:139]
    ds_read_b128 v[36:39], v109 offset:13312
    v_mfma_f32_16x16x32_bf16 v[140:143], v[44:47], v[64:67], v[140:143]
    ds_read_b128 v[40:43], v109 offset:14336
    v_mfma_f32_16x16x32_bf16 v[144:147], v[48:51], v[64:67], v[144:147]
    ds_read_b128 v[72:75], v112 offset:4096
    v_mfma_f32_16x16x32_bf16 v[148:151], v[44:47], v[68:71], v[148:151]
    ds_read_b128 v[76:79], v112 offset:6144
    v_mov_b32 v4, 2
    ds_write_b32 v9, v4
    v_mfma_f32_16x16x32_bf16 v[152:155], v[48:51], v[68:71], v[152:155]
    s_waitcnt lgkmcnt(3)
    v_mfma_f32_16x16x32_bf16 v[116:119], v[16:19], v[24:27], v[116:119]
    ds_read_b128 v[52:55], v110 offset:10240
    v_mfma_f32_16x16x32_bf16 v[120:123], v[20:23], v[24:27], v[120:123]
    ds_read_b128 v[56:59], v110 offset:11264
    v_mfma_f32_16x16x32_bf16 v[124:127], v[16:19], v[28:31], v[124:127]
    ds_read_b128 v[60:63], v110 offset:12288
    v_mfma_f32_16x16x32_bf16 v[128:131], v[20:23], v[28:31], v[128:131]
    ds_read_b128 v[64:67], v110 offset:13312
    v_mfma_f32_16x16x32_bf16 v[132:135], v[16:19], v[32:35], v[132:135]
    ds_read_b128 v[68:71], v110 offset:14336
    v_mfma_f32_16x16x32_bf16 v[136:139], v[20:23], v[32:35], v[136:139]
    s_waitcnt lgkmcnt(5)
    s_add_u32 m0, s75, 4096
    s_add_u32 s90, s73, s70
    buffer_load_dwordx4 v100, s[8:11], s90 offen lds
    v_mfma_f32_16x16x32_bf16 v[140:143], v[16:19], v[36:39], v[140:143]
    buffer_load_dwordx4 v101, s[8:11], s90 offen offset:1024 lds
    v_mfma_f32_16x16x32_bf16 v[144:147], v[20:23], v[36:39], v[144:147]
    buffer_load_dwordx4 v102, s[8:11], s90 offen offset:2048 lds
    v_mfma_f32_16x16x32_bf16 v[148:151], v[16:19], v[40:43], v[148:151]
    buffer_load_dwordx4 v103, s[8:11], s90 offen offset:3072 lds
    v_mfma_f32_16x16x32_bf16 v[152:155], v[20:23], v[40:43], v[152:155]
    ds_read_b128 v[232:235], v11 offset:0
    s_waitcnt vmcnt(13) lgkmcnt(0)
    v_mfma_f32_16x16x32_bf16 v[116:119], v[72:75], v[52:55], v[116:119]
    s_mov_b32 s89, 0
    s_nop 6
G_W2_L:
    v_min3_u32 v232, v232, v233, v234
    v_min_u32 v232, v232, v235
    v_cmp_gt_u32 vcc, 2, v232
    s_nop 3
    s_cbranch_vccz G_W2_D
    s_add_u32 s89, s89, 1
    s_cmp_ge_u32 s89, 320000
    s_cbranch_scc1 G_W2_D
    ds_read_b128 v[232:235], v11 offset:0
    s_waitcnt lgkmcnt(0)
    s_branch G_W2_L
    s_nop 0
G_W2_D:
    v_mfma_f32_16x16x32_bf16 v[120:123], v[76:79], v[52:55], v[120:123]
    ds_read_b128 v[16:19], v111 offset:8192
    v_mfma_f32_16x16x32_bf16 v[124:127], v[72:75], v[56:59], v[124:127]
    ds_read_b128 v[20:23], v111 offset:10240
    v_mfma_f32_16x16x32_bf16 v[128:131], v[76:79], v[56:59], v[128:131]
    ds_read_b128 v[24:27], v109 offset:20480
    v_mfma_f32_16x16x32_bf16 v[132:135], v[72:75], v[60:63], v[132:135]
    ds_read_b128 v[28:31], v109 offset:21504
    v_mfma_f32_16x16x32_bf16 v[136:139], v[76:79], v[60:63], v[136:139]
    ds_read_b128 v[32:35], v109 offset:22528
    v_mfma_f32_16x16x32_bf16 v[140:143], v[72:75], v[64:67], v[140:143]
    ds_read_b128 v[36:39], v109 offset:23552
    v_mfma_f32_16x16x32_bf16 v[144:147], v[76:79], v[64:67], v[144:147]
    ds_read_b128 v[40:43], v109 offset:24576
    v_mfma_f32_16x16x32_bf16 v[148:151], v[72:75], v[68:71], v[148:151]
    ds_read_b128 v[44:47], v112 offset:8192
    v_mfma_f32_16x16x32_bf16 v[152:155], v[76:79], v[68:71], v[152:155]
    ds_read_b128 v[48:51], v112 offset:10240
    s_waitcnt lgkmcnt(2)
    v_mfma_f32_16x16x32_bf16 v[116:119], v[16:19], v[24:27], v[116:119]
    ds_read_b128 v[52:55], v110 offset:20480
    s_add_u32 m0, s76, 61440
    s_add_u32 s91, s74, s71
    buffer_load_dwordx4 v104, s[12:15], s91 offen lds
    v_mfma_f32_16x16x32_bf16 v[120:123], v[20:23], v[24:27], v[120:123]
    ds_read_b128 v[56:59], v110 offset:21504
    buffer_load_dwordx4 v105, s[12:15], s91 offen offset:1024 lds
    v_mfma_f32_16x16x32_bf16 v[124:127], v[16:19], v[28:31], v[124:127]
    ds_read_b128 v[60:63], v110 offset:22528
    buffer_load_dwordx4 v106, s[12:15], s91 offen offset:2048 lds
    v_mfma_f32_16x16x32_bf16 v[128:131], v[20:23], v[28:31], v[128:131]
    ds_read_b128 v[64:67], v110 offset:23552
    buffer_load_dwordx4 v107, s[12:15], s91 offen offset:3072 lds
    v_mfma_f32_16x16x32_bf16 v[132:135], v[16:19], v[32:35], v[132:135]
    ds_read_b128 v[68:71], v110 offset:24576
    s_add_u32 m0, s76, 65536
    s_nop 0
    buffer_load_dwordx4 v108, s[12:15], s91 offen lds
    v_mfma_f32_16x16x32_bf16 v[136:139], v[20:23], v[32:35], v[136:139]
    s_waitcnt lgkmcnt(5)
    s_add_u32 m0, s75, 8192
    s_add_u32 s90, s73, s70
    s_add_u32 s90, s90, 128
    buffer_load_dwordx4 v100, s[8:11], s90 offen lds
    v_mfma_f32_16x16x32_bf16 v[140:143], v[16:19], v[36:39], v[140:143]
    buffer_load_dwordx4 v101, s[8:11], s90 offen offset:1024 lds
    v_mfma_f32_16x16x32_bf16 v[144:147], v[20:23], v[36:39], v[144:147]
    buffer_load_dwordx4 v102, s[8:11], s90 offen offset:2048 lds
    v_mfma_f32_16x16x32_bf16 v[148:151], v[16:19], v[40:43], v[148:151]
    buffer_load_dwordx4 v103, s[8:11], s90 offen offset:3072 lds
    v_mfma_f32_16x16x32_bf16 v[152:155], v[20:23], v[40:43], v[152:155]
    s_waitcnt vmcnt(13) lgkmcnt(0)
    v_mfma_f32_16x16x32_bf16 v[116:119], v[44:47], v[52:55], v[116:119]
    ds_read_b128 v[16:19], v111 offset:0
    v_mfma_f32_16x16x32_bf16 v[120:123], v[48:51], v[52:55], v[120:123]
    ds_read_b128 v[20:23], v111 offset:2048
    v_mfma_f32_16x16x32_bf16 v[124:127], v[44:47], v[56:59], v[124:127]
    ds_read_b128 v[24:27], v109 offset:30720
    v_mfma_f32_16x16x32_bf16 v[128:131], v[48:51], v[56:59], v[128:131]
    ds_read_b128 v[28:31], v109 offset:31744
    v_mfma_f32_16x16x32_bf16 v[132:135], v[44:47], v[60:63], v[132:135]
    ds_read_b128 v[32:35], v109 offset:32768
    v_mfma_f32_16x16x32_bf16 v[136:139], v[48:51], v[60:63], v[136:139]
    ds_read_b128 v[36:39], v109 offset:33792
    v_mfma_f32_16x16x32_bf16 v[140:143], v[44:47], v[64:67], v[140:143]
    ds_read_b128 v[40:43], v109 offset:34816
    v_mfma_f32_16x16x32_bf16 v[144:147], v[48:51], v[64:67], v[144:147]
    ds_read_b128 v[72:75], v112 offset:0
    v_mfma_f32_16x16x32_bf16 v[148:151], v[44:47], v[68:71], v[148:151]
    ds_read_b128 v[76:79], v112 offset:2048
    v_mov_b32 v4, 3
    ds_write_b32 v9, v4
    v_mfma_f32_16x16x32_bf16 v[152:155], v[48:51], v[68:71], v[152:155]
    s_waitcnt lgkmcnt(3)
    v_mfma_f32_16x16x32_bf16 v[116:119], v[16:19], v[24:27], v[116:119]
    ds_read_b128 v[52:55], v110 offset:30720
    v_mfma_f32_16x16x32_bf16 v[120:123], v[20:23], v[24:27], v[120:123]
    ds_read_b128 v[56:59], v110 offset:31744
    v_mfma_f32_16x16x32_bf16 v[124:127], v[16:19], v[28:31], v[124:127]
    ds_read_b128 v[60:63], v110 offset:32768
    v_mfma_f32_16x16x32_bf16 v[128:131], v[20:23], v[28:31], v[128:131]
    ds_read_b128 v[64:67], v110 offset:33792
    v_mfma_f32_16x16x32_bf16 v[132:135], v[16:19], v[32:35], v[132:135]
    ds_read_b128 v[68:71], v110 offset:34816
    v_mfma_f32_16x16x32_bf16 v[136:139], v[20:23], v[32:35], v[136:139]
    s_waitcnt lgkmcnt(5)
    s_add_u32 m0, s75, 0
    s_add_u32 s90, s73, s71
    buffer_load_dwordx4 v100, s[8:11], s90 offen lds
    v_mfma_f32_16x16x32_bf16 v[140:143], v[16:19], v[36:39], v[140:143]
    buffer_load_dwordx4 v101, s[8:11], s90 offen offset:1024 lds
    v_mfma_f32_16x16x32_bf16 v[144:147], v[20:23], v[36:39], v[144:147]
    buffer_load_dwordx4 v102, s[8:11], s90 offen offset:2048 lds
    v_mfma_f32_16x16x32_bf16 v[148:151], v[16:19], v[40:43], v[148:151]
    buffer_load_dwordx4 v103, s[8:11], s90 offen offset:3072 lds
    v_mfma_f32_16x16x32_bf16 v[152:155], v[20:23], v[40:43], v[152:155]
    ds_read_b128 v[232:235], v11 offset:0
    s_waitcnt vmcnt(13) lgkmcnt(0)
    v_mfma_f32_16x16x32_bf16 v[116:119], v[72:75], v[52:55], v[116:119]
    s_mov_b32 s89, 0
    s_nop 6
G_W4_L:
    v_min3_u32 v232, v232, v233, v234
    v_min_u32 v232, v232, v235
    v_cmp_gt_u32 vcc, 3, v232
    s_nop 3
    s_cbranch_vccz G_W4_D
    s_add_u32 s89, s89, 1
    s_cmp_ge_u32 s89, 320000
    s_cbranch_scc1 G_W4_D
    ds_read_b128 v[232:235], v11 offset:0
    s_waitcnt lgkmcnt(0)
    s_branch G_W4_L
    s_nop 0
G_W4_D:
    v_mfma_f32_16x16x32_bf16 v[120:123], v[76:79], v[52:55], v[120:123]
    ds_read_b128 v[16:19], v111 offset:4096
    v_mfma_f32_16x16x32_bf16 v[124:127], v[72:75], v[56:59], v[124:127]
    ds_read_b128 v[20:23], v111 offset:6144
    v_mfma_f32_16x16x32_bf16 v[128:131], v[76:79], v[56:59], v[128:131]
    ds_read_b128 v[24:27], v109 offset:40960
    v_mfma_f32_16x16x32_bf16 v[132:135], v[72:75], v[60:63], v[132:135]
    ds_read_b128 v[28:31], v109 offset:41984
    v_mfma_f32_16x16x32_bf16 v[136:139], v[76:79], v[60:63], v[136:139]
    ds_read_b128 v[32:35], v109 offset:43008
    v_mfma_f32_16x16x32_bf16 v[140:143], v[72:75], v[64:67], v[140:143]
    ds_read_b128 v[36:39], v109 offset:44032
    v_mfma_f32_16x16x32_bf16 v[144:147], v[76:79], v[64:67], v[144:147]
    ds_read_b128 v[40:43], v109 offset:45056
    v_mfma_f32_16x16x32_bf16 v[148:151], v[72:75], v[68:71], v[148:151]
    ds_read_b128 v[44:47], v112 offset:4096
    v_mfma_f32_16x16x32_bf16 v[152:155], v[76:79], v[68:71], v[152:155]
    ds_read_b128 v[48:51], v112 offset:6144
    s_waitcnt lgkmcnt(2)
    v_mfma_f32_16x16x32_bf16 v[116:119], v[16:19], v[24:27], v[116:119]
    ds_read_b128 v[52:55], v110 offset:40960
    s_add_u32 m0, s76, 0
    s_add_u32 s91, s74, s72
    buffer_load_dwordx4 v104, s[12:15], s91 offen lds
    v_mfma_f32_16x16x32_bf16 v[120:123], v[20:23], v[24:27], v[120:123]
    ds_read_b128 v[56:59], v110 offset:41984
    buffer_load_dwordx4 v105, s[12:15], s91 offen offset:1024 lds
    v_mfma_f32_16x16x32_bf16 v[124:127], v[16:19], v[28:31], v[124:127]
    ds_read_b128 v[60:63], v110 offset:43008
    buffer_load_dwordx4 v106, s[12:15], s91 offen offset:2048 lds
    v_mfma_f32_16x16x32_bf16 v[128:131], v[20:23], v[28:31], v[128:131]
    ds_read_b128 v[64:67], v110 offset:44032
    buffer_load_dwordx4 v107, s[12:15], s91 offen offset:3072 lds
    v_mfma_f32_16x16x32_bf16 v[132:135], v[16:19], v[32:35], v[132:135]
    ds_read_b128 v[68:71], v110 offset:45056
    s_add_u32 m0, s76, 4096
    s_nop 0
    buffer_load_dwordx4 v108, s[12:15], s91 offen lds
    v_mfma_f32_16x16x32_bf16 v[136:139], v[20:23], v[32:35], v[136:139]
    s_waitcnt lgkmcnt(5)
    s_add_u32 m0, s75, 4096
    s_add_u32 s90, s73, s71
    s_add_u32 s90, s90, 128
    buffer_load_dwordx4 v100, s[8:11], s90 offen lds
    v_mfma_f32_16x16x32_bf16 v[140:143], v[16:19], v[36:39], v[140:143]
    buffer_load_dwordx4 v101, s[8:11], s90 offen offset:1024 lds
    v_mfma_f32_16x16x32_bf16 v[144:147], v[20:23], v[36:39], v[144:147]
    buffer_load_dwordx4 v102, s[8:11], s90 offen offset:2048 lds
    v_mfma_f32_16x16x32_bf16 v[148:151], v[16:19], v[40:43], v[148:151]
    buffer_load_dwordx4 v103, s[8:11], s90 offen offset:3072 lds
    v_mfma_f32_16x16x32_bf16 v[152:155], v[20:23], v[40:43], v[152:155]
    s_waitcnt vmcnt(13) lgkmcnt(0)
    v_mfma_f32_16x16x32_bf16 v[116:119], v[44:47], v[52:55], v[116:119]
    ds_read_b128 v[16:19], v111 offset:8192
    v_mfma_f32_16x16x32_bf16 v[120:123], v[48:51], v[52:55], v[120:123]
    ds_read_b128 v[20:23], v111 offset:10240
    v_mfma_f32_16x16x32_bf16 v[124:127], v[44:47], v[56:59], v[124:127]
    ds_read_b128 v[24:27], v109 offset:51200
    v_mfma_f32_16x16x32_bf16 v[128:131], v[48:51], v[56:59], v[128:131]
    ds_read_b128 v[28:31], v109 offset:52224
    v_mfma_f32_16x16x32_bf16 v[132:135], v[44:47], v[60:63], v[132:135]
    ds_read_b128 v[32:35], v109 offset:53248
    v_mfma_f32_16x16x32_bf16 v[136:139], v[48:51], v[60:63], v[136:139]
    ds_read_b128 v[36:39], v109 offset:54272
    v_mfma_f32_16x16x32_bf16 v[140:143], v[44:47], v[64:67], v[140:143]
    ds_read_b128 v[40:43], v109 offset:55296
    v_mfma_f32_16x16x32_bf16 v[144:147], v[48:51], v[64:67], v[144:147]
    ds_read_b128 v[72:75], v112 offset:8192
    v_mfma_f32_16x16x32_bf16 v[148:151], v[44:47], v[68:71], v[148:151]
    ds_read_b128 v[76:79], v112 offset:10240
    v_mov_b32 v4, 4
    ds_write_b32 v9, v4
    v_mfma_f32_16x16x32_bf16 v[152:155], v[48:51], v[68:71], v[152:155]
    s_waitcnt lgkmcnt(3)
    v_mfma_f32_16x16x32_bf16 v[116:119], v[16:19], v[24:27], v[116:119]
    ds_read_b128 v[52:55], v110 offset:51200
    v_mfma_f32_16x16x32_bf16 v[120:123], v[20:23], v[24:27], v[120:123]
    ds_read_b128 v[56:59], v110 offset:52224
    v_mfma_f32_16x16x32_bf16 v[124:127], v[16:19], v[28:31], v[124:127]
    ds_read_b128 v[60:63], v110 offset:53248
    v_mfma_f32_16x16x32_bf16 v[128:131], v[20:23], v[28:31], v[128:131]
    ds_read_b128 v[64:67], v110 offset:54272
    v_mfma_f32_16x16x32_bf16 v[132:135], v[16:19], v[32:35], v[132:135]
    ds_read_b128 v[68:71], v110 offset:55296
    v_mfma_f32_16x16x32_bf16 v[136:139], v[20:23], v[32:35], v[136:139]
    s_waitcnt lgkmcnt(5)
    s_add_u32 m0, s75, 8192
    s_add_u32 s90, s73, s72
    buffer_load_dwordx4 v100, s[8:11], s90 offen lds
    v_mfma_f32_16x16x32_bf16 v[140:143], v[16:19], v[36:39], v[140:143]
    buffer_load_dwordx4 v101, s[8:11], s90 offen offset:1024 lds
    v_mfma_f32_16x16x32_bf16 v[144:147], v[20:23], v[36:39], v[144:147]
    buffer_load_dwordx4 v102, s[8:11], s90 offen offset:2048 lds
    v_mfma_f32_16x16x32_bf16 v[148:151], v[16:19], v[40:43], v[148:151]
    buffer_load_dwordx4 v103, s[8:11], s90 offen offset:3072 lds
    v_mfma_f32_16x16x32_bf16 v[152:155], v[20:23], v[40:43], v[152:155]
    ds_read_b128 v[232:235], v11 offset:0
    s_waitcnt vmcnt(13) lgkmcnt(0)
    v_mfma_f32_16x16x32_bf16 v[116:119], v[72:75], v[52:55], v[116:119]
    s_mov_b32 s89, 0
    s_nop 6
G_W6_L:
    v_min3_u32 v232, v232, v233, v234
    v_min_u32 v232, v232, v235
    v_cmp_gt_u32 vcc, 4, v232
    s_nop 3
    s_cbranch_vccz G_W6_D
    s_add_u32 s89, s89, 1
    s_cmp_ge_u32 s89, 320000
    s_cbranch_scc1 G_W6_D
    ds_read_b128 v[232:235], v11 offset:0
    s_waitcnt lgkmcnt(0)
    s_branch G_W6_L
    s_nop 0
G_W6_D:
    v_add_u32 v109, 40960, v109
    v_mfma_f32_16x16x32_bf16 v[120:123], v[76:79], v[52:55], v[120:123]
    ds_read_b128 v[16:19], v111 offset:0
    v_mfma_f32_16x16x32_bf16 v[124:127], v[72:75], v[56:59], v[124:127]
    ds_read_b128 v[20:23], v111 offset:2048
    v_mfma_f32_16x16x32_bf16 v[128:131], v[76:79], v[56:59], v[128:131]
    ds_read_b128 v[24:27], v109 offset:20480
    v_mfma_f32_16x16x32_bf16 v[132:135], v[72:75], v[60:63], v[132:135]
    ds_read_b128 v[28:31], v109 offset:21504
    v_mfma_f32_16x16x32_bf16 v[136:139], v[76:79], v[60:63], v[136:139]
    ds_read_b128 v[32:35], v109 offset:22528
    v_mfma_f32_16x16x32_bf16 v[140:143], v[72:75], v[64:67], v[140:143]
    ds_read_b128 v[36:39], v109 offset:23552
    v_mfma_f32_16x16x32_bf16 v[144:147], v[76:79], v[64:67], v[144:147]
    ds_read_b128 v[40:43], v109 offset:24576
    v_mfma_f32_16x16x32_bf16 v[148:151], v[72:75], v[68:71], v[148:151]
    ds_read_b128 v[44:47], v112 offset:0
    v_mfma_f32_16x16x32_bf16 v[152:155], v[76:79], v[68:71], v[152:155]
    ds_read_b128 v[48:51], v112 offset:2048
    v_add_u32 v110, 40960, v110
    s_waitcnt lgkmcnt(2)
    v_mfma_f32_16x16x32_bf16 v[116:119], v[16:19], v[24:27], v[116:119]
    ds_read_b128 v[52:55], v110 offset:20480
    v_mfma_f32_16x16x32_bf16 v[120:123], v[20:23], v[24:27], v[120:123]
    ds_read_b128 v[56:59], v110 offset:21504
    v_mfma_f32_16x16x32_bf16 v[124:127], v[16:19], v[28:31], v[124:127]
    ds_read_b128 v[60:63], v110 offset:22528
    v_mfma_f32_16x16x32_bf16 v[128:131], v[20:23], v[28:31], v[128:131]
    ds_read_b128 v[64:67], v110 offset:23552
    v_mfma_f32_16x16x32_bf16 v[132:135], v[16:19], v[32:35], v[132:135]
    ds_read_b128 v[68:71], v110 offset:24576
    v_mfma_f32_16x16x32_bf16 v[136:139], v[20:23], v[32:35], v[136:139]
    s_waitcnt lgkmcnt(5)
    s_add_u32 m0, s75, 0
    s_add_u32 s90, s73, s72
    s_add_u32 s90, s90, 128
    buffer_load_dwordx4 v100, s[8:11], s90 offen lds
    v_mfma_f32_16x16x32_bf16 v[140:143], v[16:19], v[36:39], v[140:143]
    buffer_load_dwordx4 v101, s[8:11], s90 offen offset:1024 lds
    v_mfma_f32_16x16x32_bf16 v[144:147], v[20:23], v[36:39], v[144:147]
    buffer_load_dwordx4 v102, s[8:11], s90 offen offset:2048 lds
    v_mfma_f32_16x16x32_bf16 v[148:151], v[16:19], v[40:43], v[148:151]
    buffer_load_dwordx4 v103, s[8:11], s90 offen offset:3072 lds
    v_mfma_f32_16x16x32_bf16 v[152:155], v[20:23], v[40:43], v[152:155]
    s_waitcnt vmcnt(8) lgkmcnt(0)
    v_mfma_f32_16x16x32_bf16 v[116:119], v[44:47], v[52:55], v[116:119]
    ds_read_b128 v[16:19], v111 offset:4096
    v_mfma_f32_16x16x32_bf16 v[120:123], v[48:51], v[52:55], v[120:123]
    ds_read_b128 v[20:23], v111 offset:6144
    v_mfma_f32_16x16x32_bf16 v[124:127], v[44:47], v[56:59], v[124:127]
    ds_read_b128 v[24:27], v109 offset:30720
    v_mfma_f32_16x16x32_bf16 v[128:131], v[48:51], v[56:59], v[128:131]
    ds_read_b128 v[28:31], v109 offset:31744
    v_mfma_f32_16x16x32_bf16 v[132:135], v[44:47], v[60:63], v[132:135]
    ds_read_b128 v[32:35], v109 offset:32768
    v_mfma_f32_16x16x32_bf16 v[136:139], v[48:51], v[60:63], v[136:139]
    ds_read_b128 v[36:39], v109 offset:33792
    v_mfma_f32_16x16x32_bf16 v[140:143], v[44:47], v[64:67], v[140:143]
    ds_read_b128 v[40:43], v109 offset:34816
    v_mfma_f32_16x16x32_bf16 v[144:147], v[48:51], v[64:67], v[144:147]
    ds_read_b128 v[72:75], v112 offset:4096
    v_mfma_f32_16x16x32_bf16 v[148:151], v[44:47], v[68:71], v[148:151]
    ds_read_b128 v[76:79], v112 offset:6144
    v_mov_b32 v4, 5
    ds_write_b32 v9, v4
    v_mfma_f32_16x16x32_bf16 v[152:155], v[48:51], v[68:71], v[152:155]
    s_waitcnt lgkmcnt(3)
    v_mfma_f32_16x16x32_bf16 v[116:119], v[16:19], v[24:27], v[116:119]
    ds_read_b128 v[52:55], v110 offset:30720
    global_load_dwordx2 v[194:195], v10, s[64:65] sc1
    v_mfma_f32_16x16x32_bf16 v[120:123], v[20:23], v[24:27], v[120:123]
    ds_read_b128 v[56:59], v110 offset:31744
    v_mfma_f32_16x16x32_bf16 v[124:127], v[16:19], v[28:31], v[124:127]
    ds_read_b128 v[60:63], v110 offset:32768
    v_mfma_f32_16x16x32_bf16 v[128:131], v[20:23], v[28:31], v[128:131]
    ds_read_b128 v[64:67], v110 offset:33792
    v_mfma_f32_16x16x32_bf16 v[132:135], v[16:19], v[32:35], v[132:135]
    ds_read_b128 v[68:71], v110 offset:34816
    v_mfma_f32_16x16x32_bf16 v[136:139], v[20:23], v[32:35], v[136:139]
    s_waitcnt lgkmcnt(5)
    v_mfma_f32_16x16x32_bf16 v[140:143], v[16:19], v[36:39], v[140:143]
    v_mfma_f32_16x16x32_bf16 v[144:147], v[20:23], v[36:39], v[144:147]
    v_mfma_f32_16x16x32_bf16 v[148:151], v[16:19], v[40:43], v[148:151]
    v_mfma_f32_16x16x32_bf16 v[152:155], v[20:23], v[40:43], v[152:155]
    ds_read_b128 v[232:235], v11 offset:0
    s_waitcnt vmcnt(5) lgkmcnt(0)
    v_mfma_f32_16x16x32_bf16 v[116:119], v[72:75], v[52:55], v[116:119]
    s_mov_b32 s89, 0
    s_nop 6
G_W8_L:
    v_min3_u32 v232, v232, v233, v234
    v_min_u32 v232, v232, v235
    v_cmp_gt_u32 vcc, 5, v232
    s_nop 3
    s_cbranch_vccz G_W8_D
    s_add_u32 s89, s89, 1
    s_cmp_ge_u32 s89, 320000
    s_cbranch_scc1 G_W8_D
    ds_read_b128 v[232:235], v11 offset:0
    s_waitcnt lgkmcnt(0)
    s_branch G_W8_L
    s_nop 0
G_W8_D:
    v_subrev_u32 v109, 40960, v109
    v_mfma_f32_16x16x32_bf16 v[120:123], v[76:79], v[52:55], v[120:123]
    ds_read_b128 v[16:19], v111 offset:8192
    v_mfma_f32_16x16x32_bf16 v[124:127], v[72:75], v[56:59], v[124:127]
    ds_read_b128 v[20:23], v111 offset:10240
    v_mfma_f32_16x16x32_bf16 v[128:131], v[76:79], v[56:59], v[128:131]
    ds_read_b128 v[24:27], v109 offset:0
    v_mfma_f32_16x16x32_bf16 v[132:135], v[72:75], v[60:63], v[132:135]
    ds_read_b128 v[28:31], v109 offset:1024
    v_mfma_f32_16x16x32_bf16 v[136:139], v[76:79], v[60:63], v[136:139]
    ds_read_b128 v[32:35], v109 offset:2048
    v_mfma_f32_16x16x32_bf16 v[140:143], v[72:75], v[64:67], v[140:143]
    ds_read_b128 v[36:39], v109 offset:3072
    v_mfma_f32_16x16x32_bf16 v[144:147], v[76:79], v[64:67], v[144:147]
    ds_read_b128 v[40:43], v109 offset:4096
    v_mfma_f32_16x16x32_bf16 v[148:151], v[72:75], v[68:71], v[148:151]
    ds_read_b128 v[44:47], v112 offset:8192
    v_mfma_f32_16x16x32_bf16 v[152:155], v[76:79], v[68:71], v[152:155]
    ds_read_b128 v[48:51], v112 offset:10240
    v_subrev_u32 v110, 40960, v110
    s_waitcnt lgkmcnt(2)
    v_mfma_f32_16x16x32_bf16 v[116:119], v[16:19], v[24:27], v[116:119]
    ds_read_b128 v[52:55], v110 offset:0
    v_mfma_f32_16x16x32_bf16 v[120:123], v[20:23], v[24:27], v[120:123]
    ds_read_b128 v[56:59], v110 offset:1024
    v_mfma_f32_16x16x32_bf16 v[124:127], v[16:19], v[28:31], v[124:127]
    ds_read_b128 v[60:63], v110 offset:2048
    v_mfma_f32_16x16x32_bf16 v[128:131], v[20:23], v[28:31], v[128:131]
    ds_read_b128 v[64:67], v110 offset:3072
    v_mfma_f32_16x16x32_bf16 v[132:135], v[16:19], v[32:35], v[132:135]
    ds_read_b128 v[68:71], v110 offset:4096
    v_mfma_f32_16x16x32_bf16 v[136:139], v[20:23], v[32:35], v[136:139]
    s_waitcnt lgkmcnt(5)
    v_mfma_f32_16x16x32_bf16 v[140:143], v[16:19], v[36:39], v[140:143]
    v_mfma_f32_16x16x32_bf16 v[144:147], v[20:23], v[36:39], v[144:147]
    v_mfma_f32_16x16x32_bf16 v[148:151], v[16:19], v[40:43], v[148:151]
    v_mfma_f32_16x16x32_bf16 v[152:155], v[20:23], v[40:43], v[152:155]
    s_waitcnt vmcnt(1) lgkmcnt(0)
    v_mfma_f32_16x16x32_bf16 v[116:119], v[44:47], v[52:55], v[116:119]
    ds_read_b128 v[16:19], v111 offset:0
    v_mfma_f32_16x16x32_bf16 v[120:123], v[48:51], v[52:55], v[120:123]
    ds_read_b128 v[20:23], v111 offset:2048
    v_mfma_f32_16x16x32_bf16 v[124:127], v[44:47], v[56:59], v[124:127]
    ds_read_b128 v[24:27], v109 offset:10240
    v_mfma_f32_16x16x32_bf16 v[128:131], v[48:51], v[56:59], v[128:131]
    ds_read_b128 v[28:31], v109 offset:11264
    v_mfma_f32_16x16x32_bf16 v[132:135], v[44:47], v[60:63], v[132:135]
    ds_read_b128 v[32:35], v109 offset:12288
    v_mfma_f32_16x16x32_bf16 v[136:139], v[48:51], v[60:63], v[136:139]
    ds_read_b128 v[36:39], v109 offset:13312
    v_mfma_f32_16x16x32_bf16 v[140:143], v[44:47], v[64:67], v[140:143]
    ds_read_b128 v[40:43], v109 offset:14336
    v_mfma_f32_16x16x32_bf16 v[144:147], v[48:51], v[64:67], v[144:147]
    ds_read_b128 v[72:75], v112 offset:0
    v_mfma_f32_16x16x32_bf16 v[148:151], v[44:47], v[68:71], v[148:151]
    ds_read_b128 v[76:79], v112 offset:2048
    v_mfma_f32_16x16x32_bf16 v[152:155], v[48:51], v[68:71], v[152:155]
    s_waitcnt lgkmcnt(2)
    v_mfma_f32_16x16x32_bf16 v[116:119], v[16:19], v[24:27], v[116:119]
    ds_read_b128 v[52:55], v110 offset:10240
    v_mfma_f32_16x16x32_bf16 v[120:123], v[20:23], v[24:27], v[120:123]
    ds_read_b128 v[56:59], v110 offset:11264
    v_mfma_f32_16x16x32_bf16 v[124:127], v[16:19], v[28:31], v[124:127]
    ds_read_b128 v[60:63], v110 offset:12288
    v_mfma_f32_16x16x32_bf16 v[128:131], v[20:23], v[28:31], v[128:131]
    ds_read_b128 v[64:67], v110 offset:13312
    v_mfma_f32_16x16x32_bf16 v[132:135], v[16:19], v[32:35], v[132:135]
    ds_read_b128 v[68:71], v110 offset:14336
    v_mfma_f32_16x16x32_bf16 v[136:139], v[20:23], v[32:35], v[136:139]
    s_waitcnt lgkmcnt(5)
    v_mfma_f32_16x16x32_bf16 v[140:143], v[16:19], v[36:39], v[140:143]
    v_mfma_f32_16x16x32_bf16 v[144:147], v[20:23], v[36:39], v[144:147]
    v_mfma_f32_16x16x32_bf16 v[148:151], v[16:19], v[40:43], v[148:151]
    v_mfma_f32_16x16x32_bf16 v[152:155], v[20:23], v[40:43], v[152:155]
    s_waitcnt lgkmcnt(0)
    v_lshrrev_b32 v4, 1, v3
    v_lshlrev_b32 v4, 3, v4
    v_add_u32 v4, 161792, v4
    ds_read_b64 v[156:157], v4 offset:0
    ds_read_b64 v[158:159], v4 offset:64
    ds_read_b64 v[160:161], v4 offset:128
    ds_read_b64 v[162:163], v4 offset:192
    ds_read_b64 v[164:165], v4 offset:256
    v_mfma_f32_16x16x32_bf16 v[116:119], v[72:75], v[52:55], v[116:119]
    v_mfma_f32_16x16x32_bf16 v[120:123], v[76:79], v[52:55], v[120:123]
    v_mfma_f32_16x16x32_bf16 v[124:127], v[72:75], v[56:59], v[124:127]
    v_mfma_f32_16x16x32_bf16 v[128:131], v[76:79], v[56:59], v[128:131]
    v_mfma_f32_16x16x32_bf16 v[132:135], v[72:75], v[60:63], v[132:135]
    v_mfma_f32_16x16x32_bf16 v[136:139], v[76:79], v[60:63], v[136:139]
    v_mfma_f32_16x16x32_bf16 v[140:143], v[72:75], v[64:67], v[140:143]
    v_mfma_f32_16x16x32_bf16 v[144:147], v[76:79], v[64:67], v[144:147]
    v_mfma_f32_16x16x32_bf16 v[148:151], v[72:75], v[68:71], v[148:151]
    v_mfma_f32_16x16x32_bf16 v[152:155], v[76:79], v[68:71], v[152:155]
    v_not_b32 v5, v3
    v_lshlrev_b32 v5, 31, v5
    s_waitcnt lgkmcnt(0)
    v_xor_b32 v157, v5, v157
    v_xor_b32 v159, v5, v159
    v_xor_b32 v161, v5, v161
    v_xor_b32 v163, v5, v163
    v_xor_b32 v165, v5, v165
    v_fmac_f32 v117, v156, v116
    v_fmac_f32 v125, v158, v124
    v_fmac_f32 v133, v160, v132
    v_fmac_f32 v141, v162, v140
    v_fmac_f32 v149, v164, v148
    v_fmac_f32_dpp v117, v116, v157 quad_perm:[1,0,3,2] row_mask:0xf bank_mask:0xf
    v_fmac_f32_dpp v125, v124, v159 quad_perm:[1,0,3,2] row_mask:0xf bank_mask:0xf
    v_fmac_f32_dpp v133, v132, v161 quad_perm:[1,0,3,2] row_mask:0xf bank_mask:0xf
    v_fmac_f32_dpp v141, v140, v163 quad_perm:[1,0,3,2] row_mask:0xf bank_mask:0xf
    v_fmac_f32_dpp v149, v148, v165 quad_perm:[1,0,3,2] row_mask:0xf bank_mask:0xf
    v_fmac_f32 v118, v156, v117
    v_fmac_f32 v126, v158, v125
    v_fmac_f32 v134, v160, v133
    v_fmac_f32 v142, v162, v141
    v_fmac_f32 v150, v164, v149
    v_fmac_f32_dpp v118, v117, v157 quad_perm:[1,0,3,2] row_mask:0xf bank_mask:0xf
    v_fmac_f32_dpp v126, v125, v159 quad_perm:[1,0,3,2] row_mask:0xf bank_mask:0xf
    v_fmac_f32_dpp v134, v133, v161 quad_perm:[1,0,3,2] row_mask:0xf bank_mask:0xf
    v_fmac_f32_dpp v142, v141, v163 quad_perm:[1,0,3,2] row_mask:0xf bank_mask:0xf
    v_fmac_f32_dpp v150, v149, v165 quad_perm:[1,0,3,2] row_mask:0xf bank_mask:0xf
    v_fmac_f32 v119, v156, v118
    v_fmac_f32 v127, v158, v126
    v_fmac_f32 v135, v160, v134
    v_fmac_f32 v143, v162, v142
    v_fmac_f32 v151, v164, v150
    v_fmac_f32_dpp v119, v118, v157 quad_perm:[1,0,3,2] row_mask:0xf bank_mask:0xf
    v_fmac_f32_dpp v127, v126, v159 quad_perm:[1,0,3,2] row_mask:0xf bank_mask:0xf
    v_fmac_f32_dpp v135, v134, v161 quad_perm:[1,0,3,2] row_mask:0xf bank_mask:0xf
    v_fmac_f32_dpp v143, v142, v163 quad_perm:[1,0,3,2] row_mask:0xf bank_mask:0xf
    v_fmac_f32_dpp v151, v150, v165 quad_perm:[1,0,3,2] row_mask:0xf bank_mask:0xf
    v_fmac_f32 v120, v156, v119
    v_fmac_f32 v128, v158, v127
    v_fmac_f32 v136, v160, v135
    v_fmac_f32 v144, v162, v143
    v_fmac_f32 v152, v164, v151
    v_fmac_f32_dpp v120, v119, v157 quad_perm:[1,0,3,2] row_mask:0xf bank_mask:0xf
    v_fmac_f32_dpp v128, v127, v159 quad_perm:[1,0,3,2] row_mask:0xf bank_mask:0xf
    v_fmac_f32_dpp v136, v135, v161 quad_perm:[1,0,3,2] row_mask:0xf bank_mask:0xf
    v_fmac_f32_dpp v144, v143, v163 quad_perm:[1,0,3,2] row_mask:0xf bank_mask:0xf
    v_fmac_f32_dpp v152, v151, v165 quad_perm:[1,0,3,2] row_mask:0xf bank_mask:0xf
    v_fmac_f32 v121, v156, v120
    v_fmac_f32 v129, v158, v128
    v_fmac_f32 v137, v160, v136
    v_fmac_f32 v145, v162, v144
    v_fmac_f32 v153, v164, v152
    v_fmac_f32_dpp v121, v120, v157 quad_perm:[1,0,3,2] row_mask:0xf bank_mask:0xf
    v_fmac_f32_dpp v129, v128, v159 quad_perm:[1,0,3,2] row_mask:0xf bank_mask:0xf
    v_fmac_f32_dpp v137, v136, v161 quad_perm:[1,0,3,2] row_mask:0xf bank_mask:0xf
    v_fmac_f32_dpp v145, v144, v163 quad_perm:[1,0,3,2] row_mask:0xf bank_mask:0xf
    v_fmac_f32_dpp v153, v152, v165 quad_perm:[1,0,3,2] row_mask:0xf bank_mask:0xf
    v_fmac_f32 v122, v156, v121
    v_fmac_f32 v130, v158, v129
    v_fmac_f32 v138, v160, v137
    v_fmac_f32 v146, v162, v145
    v_fmac_f32 v154, v164, v153
    v_fmac_f32_dpp v122, v121, v157 quad_perm:[1,0,3,2] row_mask:0xf bank_mask:0xf
    v_fmac_f32_dpp v130, v129, v159 quad_perm:[1,0,3,2] row_mask:0xf bank_mask:0xf
    v_fmac_f32_dpp v138, v137, v161 quad_perm:[1,0,3,2] row_mask:0xf bank_mask:0xf
    v_fmac_f32_dpp v146, v145, v163 quad_perm:[1,0,3,2] row_mask:0xf bank_mask:0xf
    v_fmac_f32_dpp v154, v153, v165 quad_perm:[1,0,3,2] row_mask:0xf bank_mask:0xf
    v_fmac_f32 v123, v156, v122
    v_fmac_f32 v131, v158, v130
    v_fmac_f32 v139, v160, v138
    v_fmac_f32 v147, v162, v146
    v_fmac_f32 v155, v164, v154
    v_fmac_f32_dpp v123, v122, v157 quad_perm:[1,0,3,2] row_mask:0xf bank_mask:0xf
    v_fmac_f32_dpp v131, v130, v159 quad_perm:[1,0,3,2] row_mask:0xf bank_mask:0xf
    v_fmac_f32_dpp v139, v138, v161 quad_perm:[1,0,3,2] row_mask:0xf bank_mask:0xf
    v_fmac_f32_dpp v147, v146, v163 quad_perm:[1,0,3,2] row_mask:0xf bank_mask:0xf
    v_fmac_f32_dpp v155, v154, v165 quad_perm:[1,0,3,2] row_mask:0xf bank_mask:0xf
    ds_write_b32 v230, v123 offset:0
    ds_write_b32 v230, v131 offset:64
    ds_write_b32 v230, v139 offset:128
    ds_write_b32 v230, v147 offset:192
    ds_write_b32 v230, v155 offset:256
    s_waitcnt vmcnt(0) lgkmcnt(0)
    v_mov_b32 v232, 6
    ds_write_b32 v9, v232
    v_cmp_eq_u32 vcc, 0, v194
    v_cmp_ne_u32 s[86:87], 8, v195
    s_nop 0
    s_or_b64 vcc, vcc, s[86:87]
    s_mov_b32 s89, 0
    s_nop 1
G_NON_L:
    s_cbranch_vccz G_NON_D
    s_add_u32 s89, s89, 1
    s_cmp_ge_u32 s89, 40000
    s_cbranch_scc1 G_NON_D
    s_sleep 8
    global_load_dwordx2 v[194:195], v10, s[64:65] sc1
    s_waitcnt vmcnt(0)
    v_cmp_eq_u32 vcc, 0, v194
    v_cmp_ne_u32 s[86:87], 8, v195
    s_nop 0
    s_or_b64 vcc, vcc, s[86:87]
    s_nop 1
    s_branch G_NON_L
    s_nop 0
G_NON_D:
    v_readfirstlane_b32 s43, v194
    ds_read_b128 v[232:235], v11 offset:0
    s_waitcnt lgkmcnt(0)
    s_mov_b32 s89, 0
    s_nop 1
G_E_L:
    v_min3_u32 v232, v232, v233, v234
    v_min_u32 v232, v232, v235
    v_cmp_gt_u32 vcc, 6, v232
    s_nop 3
    s_cbranch_vccz G_E_D
    s_add_u32 s89, s89, 1
    s_cmp_ge_u32 s89, 320000
    s_cbranch_scc1 G_E_D
    ds_read_b128 v[232:235], v11 offset:0
    s_waitcnt lgkmcnt(0)
    s_branch G_E_L
    s_nop 0
G_E_D:
    ds_read_b64 v[210:211], v13 offset:0
    ds_read_b64 v[212:213], v13 offset:336
    ds_read_b64 v[214:215], v13 offset:672
    ds_read_b64 v[216:217], v13 offset:1008
    s_mov_b32 s86, 0x11111111
    s_mov_b32 s87, 0x11111111
    s_mov_b32 s90, 0x33333333
    s_mov_b32 s91, 0x33333333
    v_mov_b32 v185, s43
    v_mov_b32 v187, s43
    s_waitcnt lgkmcnt(0)
    v_pk_fma_f32 v[180:181], v[210:211], v[196:197], v[212:213] op_sel:[0,0,0] op_sel_hi:[1,0,1]
    v_pk_fma_f32 v[180:181], v[210:211], v[196:197], v[180:181] op_sel:[1,1,0] op_sel_hi:[0,1,1] neg_lo:[0,1,0]
    v_pk_fma_f32 v[182:183], v[180:181], v[196:197], v[214:215] op_sel:[0,0,0] op_sel_hi:[1,0,1]
    v_pk_fma_f32 v[182:183], v[180:181], v[196:197], v[182:183] op_sel:[1,1,0] op_sel_hi:[0,1,1] neg_lo:[0,1,0]
    v_pk_fma_f32 v[176:177], v[182:183], v[196:197], v[216:217] op_sel:[0,0,0] op_sel_hi:[1,0,1]
    v_pk_fma_f32 v[176:177], v[182:183], v[196:197], v[176:177] op_sel:[1,1,0] op_sel_hi:[0,1,1] neg_lo:[0,1,0]
    s_nop 1
    v_mov_b32_dpp v178, v176 quad_perm:[0,0,1,2] row_mask:0xf bank_mask:0xf
    v_mov_b32_dpp v179, v177 quad_perm:[0,0,1,2] row_mask:0xf bank_mask:0xf
    v_cndmask_b32 v178, v178, 0, s[86:87]
    v_cndmask_b32 v179, v179, 0, s[86:87]
    v_pk_fma_f32 v[176:177], v[178:179], v[226:227], v[176:177] op_sel:[0,0,0] op_sel_hi:[1,0,1]
    v_pk_fma_f32 v[176:177], v[178:179], v[226:227], v[176:177] op_sel:[1,1,0] op_sel_hi:[0,1,1] neg_lo:[0,1,0]
    s_nop 1
    v_mov_b32_dpp v178, v176 quad_perm:[0,1,0,1] row_mask:0xf bank_mask:0xf
    v_mov_b32_dpp v179, v177 quad_perm:[0,1,0,1] row_mask:0xf bank_mask:0xf
    v_cndmask_b32 v178, v178, 0, s[90:91]
    v_cndmask_b32 v179, v179, 0, s[90:91]
    v_pk_fma_f32 v[176:177], v[178:179], v[228:229], v[176:177] op_sel:[0,0,0] op_sel_hi:[1,0,1]
    v_pk_fma_f32 v[176:177], v[178:179], v[228:229], v[176:177] op_sel:[1,1,0] op_sel_hi:[0,1,1] neg_lo:[0,1,0]
    v_mov_b32 v184, v176
    v_mov_b32 v186, v177
    buffer_store_dwordx4 v[184:187], v12, s[4:7], s93 offen sc0 sc1
    v_mov_b32_dpp v208, v176 quad_perm:[0,0,1,2] row_mask:0xf bank_mask:0xf
    v_mov_b32_dpp v209, v177 quad_perm:[0,0,1,2] row_mask:0xf bank_mask:0xf
    v_cndmask_b32 v208, v208, 0, s[86:87]
    v_cndmask_b32 v209, v209, 0, s[86:87]
    s_mul_i32 s33, s24, 10816
    s_add_u32 s33, s33, 55296
    v_mul_u32_u24 v226, 2688, v2
    v_lshl_add_u32 v226, v3, 2, v226
    v_add_u32 v226, s33, v226
    v_add_u32 v227, 672, v226
    v_add_u32 v228, 1344, v226
    v_add_u32 v229, 2016, v226
    v_and_b32 v168, 3, v0
    v_cvt_f32_u32 v169, v168
    v_fma_f32 v174, 2.0, v169, 1.0
    v_mul_f32 v190, v174, v166
    v_mul_f32 v191, v174, v167
    v_fract_f32 v188, v191
    v_exp_f32 v189, v190
    v_cos_f32 v222, v188
    v_sin_f32 v223, v188
    v_mul_f32 v222, v222, v189
    v_mul_f32 v223, v223, v189
    v_fma_f32 v174, 2.0, v169, 2.0
    v_mul_f32 v190, v174, v166
    v_mul_f32 v191, v174, v167
    v_fract_f32 v188, v191
    v_exp_f32 v189, v190
    v_cos_f32 v224, v188
    v_sin_f32 v225, v188
    v_mul_f32 v224, v224, v189
    v_mul_f32 v225, v225, v189
    v_lshlrev_b32 v168, 2, v168
    v_sub_u32 v170, s25, v168
    v_mul_u32_u24 v171, 640, v168
    v_lshrrev_b32 v172, 2, v0
    v_lshl_add_u32 v171, v172, 4, v171
    v_cmp_gt_u32 vcc, 40, v172
    s_nop 1
    v_cndmask_b32 v170, 0, v170, vcc
    v_mov_b32 v172, 1073741824
    v_cmp_le_i32 vcc, 1, v170
    s_nop 1
    v_cndmask_b32 v218, v172, v171, vcc
    v_cmp_le_i32 vcc, 2, v170
    s_nop 1
    v_cndmask_b32 v219, v172, v171, vcc
    v_cmp_le_i32 vcc, 3, v170
    s_nop 1
    v_cndmask_b32 v220, v172, v171, vcc
    v_cmp_le_i32 vcc, 4, v170
    s_nop 1
    v_cndmask_b32 v221, v172, v171, vcc
    s_mul_i32 s41, s28, 5
    s_add_u32 s41, s41, 80
    s_lshl_b32 s41, s41, 2
    s_add_u32 s41, s41, s24
    s_lshl_b32 s41, s41, 7
    s_add_u32 s41, s41, 12337152
    s_mul_i32 s73, s28, 204800
    s_mul_i32 s33, s42, 5120
    s_add_u32 s73, s73, s33
    s_add_u32 s73, s73, 10510336
    v_mov_b32 v252, 0
    v_lshlrev_b32 v4, 9, v1
    s_mov_b64 exec, 31
    buffer_atomic_add v252, v4, s[4:7], s41 offen sc0 sc1
    s_mov_b64 exec, -1
    ds_write2_b32 v226, v116, v117 offset0:0 offset1:84
    ds_write2_b32 v226, v124, v125 offset0:16 offset1:100
    ds_write2_b32 v226, v132, v133 offset0:32 offset1:116
    ds_write2_b32 v226, v140, v141 offset0:48 offset1:132
    ds_write2_b32 v226, v148, v149 offset0:64 offset1:148
    s_waitcnt lgkmcnt(5)
    ds_write2_b32 v227, v118, v119 offset0:0 offset1:84
    ds_write2_b32 v227, v126, v127 offset0:16 offset1:100
    ds_write2_b32 v227, v134, v135 offset0:32 offset1:116
    ds_write2_b32 v227, v142, v143 offset0:48 offset1:132
    ds_write2_b32 v227, v150, v151 offset0:64 offset1:148
    s_waitcnt lgkmcnt(5)
    ds_write2_b32 v228, v120, v121 offset0:0 offset1:84
    ds_write2_b32 v228, v128, v129 offset0:16 offset1:100
    ds_write2_b32 v228, v136, v137 offset0:32 offset1:116
    ds_write2_b32 v228, v144, v145 offset0:48 offset1:132
    ds_write2_b32 v228, v152, v153 offset0:64 offset1:148
    s_waitcnt lgkmcnt(5)
    ds_write2_b32 v229, v122, v123 offset0:0 offset1:84
    ds_write2_b32 v229, v130, v131 offset0:16 offset1:100
    ds_write2_b32 v229, v138, v139 offset0:32 offset1:116
    ds_write2_b32 v229, v146, v147 offset0:48 offset1:132
    ds_write2_b32 v229, v154, v155 offset0:64 offset1:148
    s_waitcnt lgkmcnt(5)
    v_and_b32 v4, 3, v0
    v_mul_u32_u24 v4, 640, v4
    v_lshrrev_b32 v5, 2, v0
    v_cmp_gt_u32 vcc, 40, v5
    v_lshl_add_u32 v4, v5, 3, v4
    s_and_saveexec_b64 s[86:87], vcc
    ds_write_b64 v4, v[222:223] offset:52224
    ds_write_b64 v4, v[224:225] offset:52544
    s_mov_b64 exec, s[86:87]
    s_waitcnt lgkmcnt(0)
    v_mov_b32 v232, 7
    ds_write_b32 v9, v232
    s_mul_i32 s92, s26, 10240
    s_add_u32 s92, s92, 12165120
    s_waitcnt vmcnt(0)
    v_cmp_gt_u32 vcc, 20, v252
    s_nop 0
    s_and_b64 s[86:87], vcc, 31
    s_mov_b32 s75, s86
    s_cmp_lg_u32 s75, 0
    s_cbranch_scc1 G_N0
    s_add_u32 s96, s73, 0
    buffer_load_dwordx4 v[16:19], v6, s[4:7], s96 offen offset:0 sc1
    buffer_load_dwordx4 v[20:23], v6, s[4:7], s96 offen offset:1024 sc1
    buffer_load_dwordx4 v[24:27], v6, s[4:7], s96 offen offset:2048 sc1
    buffer_load_dwordx4 v[28:31], v6, s[4:7], s96 offen offset:3072 sc1
    s_add_u32 s96, s96, 4096
    buffer_load_dwordx4 v[32:35], v6, s[4:7], s96 offen offset:0 sc1
    s_add_u32 s96, s73, 40960
    buffer_load_dwordx4 v[36:39], v6, s[4:7], s96 offen offset:0 sc1
    buffer_load_dwordx4 v[40:43], v6, s[4:7], s96 offen offset:1024 sc1
    buffer_load_dwordx4 v[44:47], v6, s[4:7], s96 offen offset:2048 sc1
    buffer_load_dwordx4 v[48:51], v6, s[4:7], s96 offen offset:3072 sc1
    s_add_u32 s96, s96, 4096
    buffer_load_dwordx4 v[52:55], v6, s[4:7], s96 offen offset:0 sc1
    s_add_u32 s96, s73, 81920
    buffer_load_dwordx4 v[56:59], v6, s[4:7], s96 offen offset:0 sc1
    buffer_load_dwordx4 v[60:63], v6, s[4:7], s96 offen offset:1024 sc1
    s_nop 1
G_N0:
    buffer_load_dwordx4 v[236:239], v218, s[4:7], s92 offen offset:0 sc1
    buffer_load_dwordx4 v[240:243], v219, s[4:7], s92 offen offset:640 sc1
    buffer_load_dwordx4 v[244:247], v220, s[4:7], s92 offen offset:1280 sc1
    buffer_load_dwordx4 v[248:251], v221, s[4:7], s92 offen offset:1920 sc1
    v_mul_f32 v169, 0x42000000, v169
    v_mul_f32 v190, v169, v166
    v_mul_f32 v191, v169, v167
    v_fract_f32 v188, v191
    v_exp_f32 v189, v190
    v_cos_f32 v198, v188
    v_sin_f32 v199, v188
    v_mul_f32 v198, v198, v189
    v_mul_f32 v199, v199, v189
    v_subrev_u32 v173, 1, v170
    v_max_i32 v173, 0, v173
    v_cvt_f32_i32 v173, v173
    v_mul_f32 v173, 0x43000000, v173
    v_mul_f32 v190, v173, v166
    v_mul_f32 v191, v173, v167
    v_fract_f32 v188, v191
    v_exp_f32 v189, v190
    v_cos_f32 v200, v188
    v_sin_f32 v201, v188
    v_mul_f32 v200, v200, v189
    v_mul_f32 v201, v201, v189
    v_subrev_u32 v173, 2, v170
    v_max_i32 v173, 0, v173
    v_cvt_f32_i32 v173, v173
    v_mul_f32 v173, 0x43000000, v173
    v_mul_f32 v190, v173, v166
    v_mul_f32 v191, v173, v167
    v_fract_f32 v188, v191
    v_exp_f32 v189, v190
    v_cos_f32 v202, v188
    v_sin_f32 v203, v188
    v_mul_f32 v202, v202, v189
    v_mul_f32 v203, v203, v189
    v_subrev_u32 v173, 3, v170
    v_max_i32 v173, 0, v173
    v_cvt_f32_i32 v173, v173
    v_mul_f32 v173, 0x43000000, v173
    v_mul_f32 v190, v173, v166
    v_mul_f32 v191, v173, v167
    v_fract_f32 v188, v191
    v_exp_f32 v189, v190
    v_cos_f32 v204, v188
    v_sin_f32 v205, v188
    v_mul_f32 v204, v204, v189
    v_mul_f32 v205, v205, v189
    v_subrev_u32 v173, 4, v170
    v_max_i32 v173, 0, v173
    v_cvt_f32_i32 v173, v173
    v_mul_f32 v173, 0x43000000, v173
    v_mul_f32 v190, v173, v166
    v_mul_f32 v191, v173, v167
    v_fract_f32 v188, v191
    v_exp_f32 v189, v190
    v_cos_f32 v206, v188
    v_sin_f32 v207, v188
    v_mul_f32 v206, v206, v189
    v_mul_f32 v207, v207, v189
    s_mov_b32 s33, 1073741824
    v_cmp_gt_u32 vcc, s33, v218
    s_nop 1
    v_cndmask_b32 v226, 0, v185, vcc
    v_cmp_gt_u32 vcc, s33, v219
    s_nop 1
    v_cndmask_b32 v227, 0, v185, vcc
    v_cmp_gt_u32 vcc, s33, v220
    s_nop 1
    v_cndmask_b32 v228, 0, v185, vcc
    v_cmp_gt_u32 vcc, s33, v221
    s_nop 1
    v_cndmask_b32 v229, 0, v185, vcc
    v_lshrrev_b32 v4, 3, v0
    v_and_b32 v5, 3, v1
    v_mul_u32_u24 v222, 10816, v5
    v_mov_b32 v12, 336
    v_mad_u32_u24 v222, v4, v12, v222
    v_bfe_u32 v223, v1, 2, 1
    v_lshlrev_b32 v223, 5, v223
    v_add_u32 v222, v222, v223
    v_add_u32 v222, 55296, v222
    v_lshl_add_u32 v5, v5, 2, s24
    v_mad_u32_u24 v12, v5, v12, v223
    v_and_b32 v4, 7, v4
    v_mul_u32_u24 v4, 320, v4
    v_add_u32 v223, v223, v4
    ds_read_b128 v[232:235], v11 offset:0
    s_waitcnt lgkmcnt(0)
    s_mov_b32 s89, 0
    s_nop 1
G_L_L:
    v_min3_u32 v232, v232, v233, v234
    v_min_u32 v232, v232, v235
    v_cmp_gt_u32 vcc, 7, v232
    s_nop 3
    s_cbranch_vccz G_L_D
    s_add_u32 s89, s89, 1
    s_cmp_ge_u32 s89, 320000
    s_cbranch_scc1 G_L_D
    ds_read_b128 v[232:235], v11 offset:0
    s_waitcnt lgkmcnt(0)
    s_branch G_L_L
    s_nop 0
G_L_D:
    ds_read_b128 v[116:119], v222 offset:0
    ds_read_b128 v[120:123], v222 offset:16
    ds_read_b128 v[124:127], v222 offset:64
    ds_read_b128 v[128:131], v222 offset:80
    ds_read_b128 v[132:135], v222 offset:128
    ds_read_b128 v[136:139], v222 offset:144
    ds_read_b128 v[140:143], v222 offset:192
    ds_read_b128 v[144:147], v222 offset:208
    ds_read_b128 v[148:151], v222 offset:256
    ds_read_b128 v[152:155], v222 offset:272
    s_waitcnt lgkmcnt(4)
    ds_read_b128 v[156:159], v223 offset:52224
    ds_read_b128 v[160:163], v223 offset:52240
    ds_read_b128 v[164:167], v223 offset:52288
    ds_read_b128 v[168:171], v223 offset:52304
    ds_read_b128 v[172:175], v223 offset:52352
    ds_read_b128 v[176:179], v223 offset:52368
    ds_read_b128 v[180:183], v223 offset:52416
    ds_read_b128 v[184:187], v223 offset:52432
    ds_read_b128 v[188:191], v223 offset:52480
    ds_read_b128 v[192:195], v223 offset:52496
    s_waitcnt vmcnt(0) lgkmcnt(0)
    v_xor_b32 v237, v237, v226
    v_xor_b32 v239, v239, v226
    v_xor_b32 v241, v241, v227
    v_xor_b32 v243, v243, v227
    v_xor_b32 v245, v245, v228
    v_xor_b32 v247, v247, v228
    v_xor_b32 v249, v249, v229
    v_xor_b32 v251, v251, v229
    v_or3_b32 v4, v237, v239, v241
    v_or3_b32 v5, v243, v245, v247
    v_or3_b32 v4, v249, v251, v4
    v_or_b32 v4, v4, v5
    v_cmp_ne_u32 vcc, 0, v4
    s_mov_b32 s89, 0
    s_nop 3
G_S1_L:
    s_cbranch_vccz G_S1_D
    s_add_u32 s89, s89, 1
    s_cmp_ge_u32 s89, 40000
    s_cbranch_scc1 G_S1_D
    s_sleep 4
    buffer_load_dwordx4 v[236:239], v218, s[4:7], s92 offen offset:0 sc1
    buffer_load_dwordx4 v[240:243], v219, s[4:7], s92 offen offset:640 sc1
    buffer_load_dwordx4 v[244:247], v220, s[4:7], s92 offen offset:1280 sc1
    buffer_load_dwordx4 v[248:251], v221, s[4:7], s92 offen offset:1920 sc1
    s_waitcnt vmcnt(0)
    v_xor_b32 v237, v237, v226
    v_xor_b32 v239, v239, v226
    v_xor_b32 v241, v241, v227
    v_xor_b32 v243, v243, v227
    v_xor_b32 v245, v245, v228
    v_xor_b32 v247, v247, v228
    v_xor_b32 v249, v249, v229
    v_xor_b32 v251, v251, v229
    v_or3_b32 v4, v237, v239, v241
    v_or3_b32 v5, v243, v245, v247
    v_or3_b32 v4, v249, v251, v4
    v_or_b32 v4, v4, v5
    v_cmp_ne_u32 vcc, 0, v4
    s_nop 3
    s_branch G_S1_L
    s_nop 0
G_S1_D:
    s_cmp_lg_u32 s75, 0
    s_cbranch_scc1 G_NE
    buffer_load_dwordx4 v[64:67], v6, s[4:7], s96 offen offset:2048 sc1
    buffer_load_dwordx4 v[68:71], v6, s[4:7], s96 offen offset:3072 sc1
    s_add_u32 s96, s96, 4096
    buffer_load_dwordx4 v[72:75], v6, s[4:7], s96 offen offset:0 sc1
    s_add_u32 s96, s73, 122880
    buffer_load_dwordx4 v[76:79], v6, s[4:7], s96 offen offset:0 sc1
    buffer_load_dwordx4 v[80:83], v6, s[4:7], s96 offen offset:1024 sc1
    buffer_load_dwordx4 v[84:87], v6, s[4:7], s96 offen offset:2048 sc1
    buffer_load_dwordx4 v[88:91], v6, s[4:7], s96 offen offset:3072 sc1
    s_add_u32 s96, s96, 4096
    buffer_load_dwordx4 v[92:95], v6, s[4:7], s96 offen offset:0 sc1
    s_nop 1
G_NE:
    v_mov_b32 v237, v238
    v_mov_b32 v241, v242
    v_mov_b32 v245, v246
    v_mov_b32 v249, v250
    v_pk_mul_f32 v[224:225], v[236:237], v[200:201] op_sel:[0,0] op_sel_hi:[1,0]
    v_pk_fma_f32 v[224:225], v[236:237], v[200:201], v[224:225] op_sel:[1,1,0] op_sel_hi:[0,1,1] neg_lo:[0,1,0]
    v_pk_fma_f32 v[224:225], v[240:241], v[202:203], v[224:225] op_sel:[0,0,0] op_sel_hi:[1,0,1]
    v_pk_fma_f32 v[224:225], v[240:241], v[202:203], v[224:225] op_sel:[1,1,0] op_sel_hi:[0,1,1] neg_lo:[0,1,0]
    v_pk_fma_f32 v[224:225], v[244:245], v[204:205], v[224:225] op_sel:[0,0,0] op_sel_hi:[1,0,1]
    v_pk_fma_f32 v[224:225], v[244:245], v[204:205], v[224:225] op_sel:[1,1,0] op_sel_hi:[0,1,1] neg_lo:[0,1,0]
    v_pk_fma_f32 v[224:225], v[248:249], v[206:207], v[224:225] op_sel:[0,0,0] op_sel_hi:[1,0,1]
    v_pk_fma_f32 v[224:225], v[248:249], v[206:207], v[224:225] op_sel:[1,1,0] op_sel_hi:[0,1,1] neg_lo:[0,1,0]
    s_nop 1
    v_add_f32_dpp v224, v224, v224 quad_perm:[1,0,3,2] row_mask:0xf bank_mask:0xf
    v_add_f32_dpp v225, v225, v225 quad_perm:[1,0,3,2] row_mask:0xf bank_mask:0xf
    s_nop 0
    v_add_f32_dpp v224, v224, v224 quad_perm:[2,3,0,1] row_mask:0xf bank_mask:0xf
    v_add_f32_dpp v225, v225, v225 quad_perm:[2,3,0,1] row_mask:0xf bank_mask:0xf
    v_pk_fma_f32 v[208:209], v[224:225], v[198:199], v[208:209] op_sel:[0,0,0] op_sel_hi:[1,0,1]
    v_pk_fma_f32 v[208:209], v[224:225], v[198:199], v[208:209] op_sel:[1,1,0] op_sel_hi:[0,1,1] neg_lo:[0,1,0]
    v_pk_fma_f32 v[210:211], v[208:209], v[196:197], v[210:211] op_sel:[0,0,0] op_sel_hi:[1,0,1]
    v_pk_fma_f32 v[210:211], v[208:209], v[196:197], v[210:211] op_sel:[1,1,0] op_sel_hi:[0,1,1] neg_lo:[0,1,0]
    v_pk_fma_f32 v[212:213], v[210:211], v[196:197], v[212:213] op_sel:[0,0,0] op_sel_hi:[1,0,1]
    v_pk_fma_f32 v[212:213], v[210:211], v[196:197], v[212:213] op_sel:[1,1,0] op_sel_hi:[0,1,1] neg_lo:[0,1,0]
    v_pk_fma_f32 v[214:215], v[212:213], v[196:197], v[214:215] op_sel:[0,0,0] op_sel_hi:[1,0,1]
    v_pk_fma_f32 v[214:215], v[212:213], v[196:197], v[214:215] op_sel:[1,1,0] op_sel_hi:[0,1,1] neg_lo:[0,1,0]
    v_lshrrev_b32 v5, 2, v0
    v_cmp_gt_u32 vcc, 40, v5
    s_nop 0
    s_and_saveexec_b64 s[86:87], vcc
    ds_write_b64 v13, v[208:209] offset:5632
    ds_write_b64 v13, v[210:211] offset:5968
    ds_write_b64 v13, v[212:213] offset:6304
    ds_write_b64 v13, v[214:215] offset:6640
    s_mov_b64 exec, s[86:87]
    s_waitcnt lgkmcnt(0)
    v_mov_b32 v232, 8
    ds_write_b32 v9, v232
    ds_read_b128 v[232:235], v11 offset:0
    s_waitcnt lgkmcnt(0)
    s_mov_b32 s89, 0
    s_nop 0
G_C_L:
    v_min3_u32 v232, v232, v233, v234
    v_min_u32 v232, v232, v235
    v_cmp_gt_u32 vcc, 8, v232
    s_nop 3
    s_cbranch_vccz G_C_D
    s_add_u32 s89, s89, 1
    s_cmp_ge_u32 s89, 320000
    s_cbranch_scc1 G_C_D
    ds_read_b128 v[232:235], v11 offset:0
    s_waitcnt lgkmcnt(0)
    s_branch G_C_L
    s_nop 0
G_C_D:
    ds_read_b128 v[196:199], v12 offset:46592
    ds_read_b128 v[200:203], v12 offset:46608
    ds_read_b128 v[204:207], v12 offset:46656
    ds_read_b128 v[208:211], v12 offset:46672
    ds_read_b128 v[212:215], v12 offset:46720
    ds_read_b128 v[216:219], v12 offset:46736
    ds_read_b128 v[220:223], v12 offset:46784
    ds_read_b128 v[224:227], v12 offset:46800
    ds_read_b128 v[228:231], v12 offset:46848
    ds_read_b128 v[232:235], v12 offset:46864
    s_waitcnt lgkmcnt(8)
    v_pk_fma_f32 v[116:117], v[196:197], v[156:157], v[116:117] op_sel:[0,0,0] op_sel_hi:[1,0,1]
    v_pk_fma_f32 v[116:117], v[196:197], v[156:157], v[116:117] op_sel:[1,1,0] op_sel_hi:[0,1,1] neg_lo:[0,1,0]
    v_pk_fma_f32 v[118:119], v[198:199], v[158:159], v[118:119] op_sel:[0,0,0] op_sel_hi:[1,0,1]
    v_pk_fma_f32 v[118:119], v[198:199], v[158:159], v[118:119] op_sel:[1,1,0] op_sel_hi:[0,1,1] neg_lo:[0,1,0]
    v_pk_fma_f32 v[120:121], v[200:201], v[160:161], v[120:121] op_sel:[0,0,0] op_sel_hi:[1,0,1]
    v_pk_fma_f32 v[120:121], v[200:201], v[160:161], v[120:121] op_sel:[1,1,0] op_sel_hi:[0,1,1] neg_lo:[0,1,0]
    v_pk_fma_f32 v[122:123], v[202:203], v[162:163], v[122:123] op_sel:[0,0,0] op_sel_hi:[1,0,1]
    v_pk_fma_f32 v[122:123], v[202:203], v[162:163], v[122:123] op_sel:[1,1,0] op_sel_hi:[0,1,1] neg_lo:[0,1,0]
    v_cvt_pk_bf16_f32 v196, v116, v117
    v_cvt_pk_bf16_f32 v197, v118, v119
    v_cvt_pk_bf16_f32 v198, v120, v121
    v_cvt_pk_bf16_f32 v199, v122, v123
    buffer_store_dwordx4 v[196:199], v14, s[4:7], s88 offen offset:0 sc0 sc1
    s_waitcnt lgkmcnt(6)
    v_pk_fma_f32 v[124:125], v[204:205], v[164:165], v[124:125] op_sel:[0,0,0] op_sel_hi:[1,0,1]
    v_pk_fma_f32 v[124:125], v[204:205], v[164:165], v[124:125] op_sel:[1,1,0] op_sel_hi:[0,1,1] neg_lo:[0,1,0]
    v_pk_fma_f32 v[126:127], v[206:207], v[166:167], v[126:127] op_sel:[0,0,0] op_sel_hi:[1,0,1]
    v_pk_fma_f32 v[126:127], v[206:207], v[166:167], v[126:127] op_sel:[1,1,0] op_sel_hi:[0,1,1] neg_lo:[0,1,0]
    v_pk_fma_f32 v[128:129], v[208:209], v[168:169], v[128:129] op_sel:[0,0,0] op_sel_hi:[1,0,1]
    v_pk_fma_f32 v[128:129], v[208:209], v[168:169], v[128:129] op_sel:[1,1,0] op_sel_hi:[0,1,1] neg_lo:[0,1,0]
    v_pk_fma_f32 v[130:131], v[210:211], v[170:171], v[130:131] op_sel:[0,0,0] op_sel_hi:[1,0,1]
    v_pk_fma_f32 v[130:131], v[210:211], v[170:171], v[130:131] op_sel:[1,1,0] op_sel_hi:[0,1,1] neg_lo:[0,1,0]
    v_cvt_pk_bf16_f32 v204, v124, v125
    v_cvt_pk_bf16_f32 v205, v126, v127
    v_cvt_pk_bf16_f32 v206, v128, v129
    v_cvt_pk_bf16_f32 v207, v130, v131
    buffer_store_dwordx4 v[204:207], v14, s[4:7], s88 offen offset:128 sc0 sc1
    s_waitcnt lgkmcnt(4)
    v_pk_fma_f32 v[132:133], v[212:213], v[172:173], v[132:133] op_sel:[0,0,0] op_sel_hi:[1,0,1]
    v_pk_fma_f32 v[132:133], v[212:213], v[172:173], v[132:133] op_sel:[1,1,0] op_sel_hi:[0,1,1] neg_lo:[0,1,0]
    v_pk_fma_f32 v[134:135], v[214:215], v[174:175], v[134:135] op_sel:[0,0,0] op_sel_hi:[1,0,1]
    v_pk_fma_f32 v[134:135], v[214:215], v[174:175], v[134:135] op_sel:[1,1,0] op_sel_hi:[0,1,1] neg_lo:[0,1,0]
    v_pk_fma_f32 v[136:137], v[216:217], v[176:177], v[136:137] op_sel:[0,0,0] op_sel_hi:[1,0,1]
    v_pk_fma_f32 v[136:137], v[216:217], v[176:177], v[136:137] op_sel:[1,1,0] op_sel_hi:[0,1,1] neg_lo:[0,1,0]
    v_pk_fma_f32 v[138:139], v[218:219], v[178:179], v[138:139] op_sel:[0,0,0] op_sel_hi:[1,0,1]
    v_pk_fma_f32 v[138:139], v[218:219], v[178:179], v[138:139] op_sel:[1,1,0] op_sel_hi:[0,1,1] neg_lo:[0,1,0]
    v_cvt_pk_bf16_f32 v212, v132, v133
    v_cvt_pk_bf16_f32 v213, v134, v135
    v_cvt_pk_bf16_f32 v214, v136, v137
    v_cvt_pk_bf16_f32 v215, v138, v139
    buffer_store_dwordx4 v[212:215], v14, s[4:7], s88 offen offset:256 sc0 sc1
    s_waitcnt lgkmcnt(2)
    v_pk_fma_f32 v[140:141], v[220:221], v[180:181], v[140:141] op_sel:[0,0,0] op_sel_hi:[1,0,1]
    v_pk_fma_f32 v[140:141], v[220:221], v[180:181], v[140:141] op_sel:[1,1,0] op_sel_hi:[0,1,1] neg_lo:[0,1,0]
    v_pk_fma_f32 v[142:143], v[222:223], v[182:183], v[142:143] op_sel:[0,0,0] op_sel_hi:[1,0,1]
    v_pk_fma_f32 v[142:143], v[222:223], v[182:183], v[142:143] op_sel:[1,1,0] op_sel_hi:[0,1,1] neg_lo:[0,1,0]
    v_pk_fma_f32 v[144:145], v[224:225], v[184:185], v[144:145] op_sel:[0,0,0] op_sel_hi:[1,0,1]
    v_pk_fma_f32 v[144:145], v[224:225], v[184:185], v[144:145] op_sel:[1,1,0] op_sel_hi:[0,1,1] neg_lo:[0,1,0]
    v_pk_fma_f32 v[146:147], v[226:227], v[186:187], v[146:147] op_sel:[0,0,0] op_sel_hi:[1,0,1]
    v_pk_fma_f32 v[146:147], v[226:227], v[186:187], v[146:147] op_sel:[1,1,0] op_sel_hi:[0,1,1] neg_lo:[0,1,0]
    v_cvt_pk_bf16_f32 v220, v140, v141
    v_cvt_pk_bf16_f32 v221, v142, v143
    v_cvt_pk_bf16_f32 v222, v144, v145
    v_cvt_pk_bf16_f32 v223, v146, v147
    buffer_store_dwordx4 v[220:223], v14, s[4:7], s88 offen offset:384 sc0 sc1
    s_waitcnt lgkmcnt(0)
    v_pk_fma_f32 v[148:149], v[228:229], v[188:189], v[148:149] op_sel:[0,0,0] op_sel_hi:[1,0,1]
    v_pk_fma_f32 v[148:149], v[228:229], v[188:189], v[148:149] op_sel:[1,1,0] op_sel_hi:[0,1,1] neg_lo:[0,1,0]
    v_pk_fma_f32 v[150:151], v[230:231], v[190:191], v[150:151] op_sel:[0,0,0] op_sel_hi:[1,0,1]
    v_pk_fma_f32 v[150:151], v[230:231], v[190:191], v[150:151] op_sel:[1,1,0] op_sel_hi:[0,1,1] neg_lo:[0,1,0]
    v_pk_fma_f32 v[152:153], v[232:233], v[192:193], v[152:153] op_sel:[0,0,0] op_sel_hi:[1,0,1]
    v_pk_fma_f32 v[152:153], v[232:233], v[192:193], v[152:153] op_sel:[1,1,0] op_sel_hi:[0,1,1] neg_lo:[0,1,0]
    v_pk_fma_f32 v[154:155], v[234:235], v[194:195], v[154:155] op_sel:[0,0,0] op_sel_hi:[1,0,1]
    v_pk_fma_f32 v[154:155], v[234:235], v[194:195], v[154:155] op_sel:[1,1,0] op_sel_hi:[0,1,1] neg_lo:[0,1,0]
    v_cvt_pk_bf16_f32 v228, v148, v149
    v_cvt_pk_bf16_f32 v229, v150, v151
    v_cvt_pk_bf16_f32 v230, v152, v153
    v_cvt_pk_bf16_f32 v231, v154, v155
    buffer_store_dwordx4 v[228:231], v14, s[4:7], s88 offen offset:512 sc0 sc1
    s_lshl_b32 s94, s24, 3
    s_lshr_b32 s33, s26, 1
    s_add_u32 s94, s94, s33
    s_lshl_b32 s94, s94, 2
    s_lshl_b32 s94, s94, 7
    s_add_u32 s94, s94, 12337152
    v_lshlrev_b32 v4, 3, v2
    s_lshl_b32 s33, s28, 5
    v_add_u32 v4, s33, v4
    global_load_dwordx2 v[246:247], v4, s[58:59] offset:0
    global_load_dwordx2 v[248:249], v4, s[58:59] offset:256
    global_load_dwordx2 v[250:251], v4, s[58:59] offset:512
    s_cmp_lg_u32 s75, 0
    s_cbranch_scc1 G_NM
    s_add_u32 s96, s73, 163840
    buffer_load_dwordx4 v[96:99], v6, s[4:7], s96 offen offset:0 sc1
    buffer_load_dwordx4 v[100:103], v6, s[4:7], s96 offen offset:1024 sc1
    buffer_load_dwordx4 v[104:107], v6, s[4:7], s96 offen offset:2048 sc1
    buffer_load_dwordx4 v[108:111], v6, s[4:7], s96 offen offset:3072 sc1
    s_add_u32 s96, s96, 4096
    buffer_load_dwordx4 v[112:115], v6, s[4:7], s96 offen offset:0 sc1
    s_nop 1
G_NM:
    ds_read_b128 v[176:179], v11 offset:16
    s_waitcnt lgkmcnt(0)
    s_mov_b32 s89, 0
    s_nop 0
G_XA_L:
    v_min3_u32 v176, v176, v177, v178
    v_min_u32 v176, v176, v179
    v_cmp_gt_u32 vcc, 1, v176
    s_nop 3
    s_cbranch_vccz G_XA_D
    s_add_u32 s89, s89, 1
    s_cmp_ge_u32 s89, 320000
    s_cbranch_scc1 G_XA_D
    ds_read_b128 v[176:179], v11 offset:16
    s_waitcnt lgkmcnt(0)
    s_branch G_XA_L
    s_nop 0
G_XA_D:
    s_lshl_b32 s33, s24, 9
    s_add_u32 s33, s33, 151552
    v_lshlrev_b32 v4, 5, v3
    v_lshl_add_u32 v4, v2, 3, v4
    v_add_u32 v4, s33, v4
    ds_read_b64 v[240:241], v4 offset:0
    ds_read_b64 v[242:243], v4 offset:2048
    ds_read_b64 v[244:245], v4 offset:4096
    v_bfe_u32 v236, v1, 2, 2
    v_mul_u32_u24 v236, 10240, v236
    v_lshl_add_u32 v236, v2, 6, v236
    v_and_b32 v4, 3, v1
    v_lshl_add_u32 v236, v4, 4, v236
    s_mul_i32 s90, s27, 163840
    s_mul_i32 s33, s42, 1280
    s_add_u32 s90, s90, s33
    s_add_u32 s90, s90, 8192
    s_mul_i32 s33, s28, 86
    s_lshr_b32 s33, s33, 8
    s_mul_i32 s33, s33, 3
    s_sub_u32 s92, s28, s33
    s_add_u32 s33, s92, 0
    s_cmp_ge_u32 s33, 3
    s_cselect_b32 s34, 3, 0
    s_sub_u32 s33, s33, s34
    s_add_u32 s34, s33, s24
    s_add_u32 s34, s34, 1
    s_and_b32 s34, s34, 3
    s_mul_i32 s36, s34, 40960
    s_add_u32 s36, s36, s90
    s_sub_u32 s33, s42, s34
    s_sub_u32 s33, s33, 1
    s_and_b32 s33, s33, 7
    s_lshl_b32 s33, s33, 10
    s_mul_i32 s44, s34, 35840
    s_xor_b32 s45, s33, 4096
    s_add_u32 s45, s45, s44
    s_add_u32 s44, s44, s33
    s_add_u32 s33, s92, 1
    s_cmp_ge_u32 s33, 3
    s_cselect_b32 s34, 3, 0
    s_sub_u32 s33, s33, s34
    s_add_u32 s34, s33, s24
    s_add_u32 s34, s34, 1
    s_and_b32 s34, s34, 3
    s_mul_i32 s37, s34, 40960
    s_add_u32 s37, s37, s90
    s_sub_u32 s33, s42, s34
    s_sub_u32 s33, s33, 1
    s_and_b32 s33, s33, 7
    s_lshl_b32 s33, s33, 10
    s_mul_i32 s46, s34, 35840
    s_xor_b32 s47, s33, 4096
    s_add_u32 s47, s47, s46
    s_add_u32 s46, s46, s33
    s_add_u32 s33, s92, 2
    s_cmp_ge_u32 s33, 3
    s_cselect_b32 s34, 3, 0
    s_sub_u32 s33, s33, s34
    s_add_u32 s34, s33, s24
    s_add_u32 s34, s34, 1
    s_and_b32 s34, s34, 3
    s_mul_i32 s38, s34, 40960
    s_add_u32 s38, s38, s90
    s_sub_u32 s33, s42, s34
    s_sub_u32 s33, s33, 1
    s_and_b32 s33, s33, 7
    s_lshl_b32 s33, s33, 10
    s_mul_i32 s48, s34, 35840
    s_xor_b32 s49, s33, 4096
    s_add_u32 s49, s49, s48
    s_add_u32 s48, s48, s33
    s_mov_b32 s34, s24
    s_mul_i32 s39, s34, 40960
    s_add_u32 s39, s39, s90
    s_sub_u32 s33, s42, s34
    s_sub_u32 s33, s33, 1
    s_and_b32 s33, s33, 7
    s_lshl_b32 s33, s33, 10
    s_mul_i32 s50, s34, 35840
    s_xor_b32 s51, s33, 4096
    s_add_u32 s51, s51, s50
    s_add_u32 s50, s50, s33
    v_lshlrev_b32 v195, 2, v3
    s_lshl_b32 s33, s42, 2
    v_add_u32 v4, s33, v2
    s_mov_b32 s33, 81920
    v_mad_u32_u24 v0, v4, s33, v195
    v_lshlrev_b32 v191, 4, v2
    v_mad_u32_u24 v191, v3, s33, v191
    v_lshlrev_b32 v255, 8, v3
    s_lshr_b32 s54, s27, 3
    s_lshl_b32 s54, s54, 3
    s_add_u32 s54, s54, s42
    s_and_b32 s33, s28, 3
    s_lshl_b32 s54, s54, 2
    s_add_u32 s54, s54, s33
    s_lshl_b32 s54, s54, 7
    s_add_u32 s54, s54, 12337152
    s_lshl_b32 s55, s42, 2
    s_lshr_b32 s33, s28, 1
    s_add_u32 s55, s55, s33
    s_add_u32 s55, s55, 48
    s_lshr_b32 s33, s2, 6
    s_lshl_b32 s55, s55, 2
    s_add_u32 s55, s55, s33
    s_lshl_b32 s55, s55, 7
    s_add_u32 s55, s55, 12337152
    s_cmp_eq_u32 s42, 0
    s_cselect_b32 s56, 21, 20
    s_lshl_b32 s52, s27, 9
    s_lshl_b32 s33, s28, 6
    s_add_u32 s52, s52, s33
    s_add_u32 s52, s52, 7872512
    s_lshl_b32 s53, s24, 9
    s_add_u32 s53, s53, s27
    s_lshl_b32 s33, s24, 4
    v_add_u32 v4, s33, v3
    v_cvt_f32_u32 v4, v4
    v_mul_f32 v4, 0x3c800000, v4
    v_cvt_f32_u32 v5, v2
    v_mul_f32 v5, 4.0, v5
    v_mul_f32 v5, v5, v4
    v_fmamk_f32 v216, v4, 0x00000000, v5
    v_fmamk_f32 v217, v4, 0x3f800000, v5
    v_fmamk_f32 v218, v4, 0x40000000, v5
    v_fmamk_f32 v219, v4, 0x40400000, v5
    v_fmamk_f32 v220, v4, 0x41800000, v5
    v_fmamk_f32 v221, v4, 0x41880000, v5
    v_fmamk_f32 v222, v4, 0x41900000, v5
    v_fmamk_f32 v223, v4, 0x41980000, v5
    v_cos_f32 v224, v216
    v_cos_f32 v225, v217
    v_cos_f32 v226, v218
    v_cos_f32 v227, v219
    v_cos_f32 v228, v220
    v_cos_f32 v229, v221
    v_cos_f32 v230, v222
    v_cos_f32 v231, v223
    v_sin_f32 v216, v216
    v_sin_f32 v217, v217
    v_sin_f32 v218, v218
    v_sin_f32 v219, v219
    v_sin_f32 v220, v220
    v_sin_f32 v221, v221
    v_sin_f32 v222, v222
    v_sin_f32 v223, v223
    v_cvt_pk_bf16_f32 v176, v224, -v216
    v_cvt_pk_bf16_f32 v177, v225, -v217
    v_cvt_pk_bf16_f32 v178, v226, -v218
    v_cvt_pk_bf16_f32 v179, v227, -v219
    v_cvt_pk_bf16_f32 v180, v228, -v220
    v_cvt_pk_bf16_f32 v181, v229, -v221
    v_cvt_pk_bf16_f32 v182, v230, -v222
    v_cvt_pk_bf16_f32 v183, v231, -v223
    v_lshlrev_b32 v4, 31, v3
    v_or_b32 v4, 0x3f003f00, v4
    v_cmp_eq_u32 vcc, 0, v2
    s_nop 1
    v_cndmask_b32 v176, v176, v4, vcc
    v_add_u32 v5, s28, v3
    v_mul_u32_u24 v5, 3, v5
    v_mul_u32_u24 v216, 205, v5
    v_lshrrev_b32 v216, 10, v216
    v_mul_u32_u24 v216, 5, v216
    v_sub_u32 v5, v5, v216
    v_mul_u32_u24 v184, 2304, v5
    v_add_u32 v185, 4608, v184
    v_subrev_u32 v216, 11520, v185
    v_min_u32 v185, v185, v216
    v_add_u32 v186, 4608, v185
    v_subrev_u32 v216, 11520, v186
    v_min_u32 v186, v186, v216
    v_add_u32 v187, 4608, v186
    v_subrev_u32 v216, 11520, v187
    v_min_u32 v187, v187, v216
    v_add_u32 v188, 4608, v187
    v_subrev_u32 v216, 11520, v188
    v_min_u32 v188, v188, v216
    v_mul_u32_u24 v4, 144, v3
    v_lshl_add_u32 v5, v2, 2, v4
    s_lshl_b32 s33, s42, 4
    s_add_u32 s33, s33, 143360
    v_add_u32 v5, s33, v5
    v_add_u32 v184, v184, v5
    v_add_u32 v185, v185, v5
    v_add_u32 v186, v186, v5
    v_add_u32 v187, v187, v5
    v_add_u32 v188, v188, v5
    v_lshl_add_u32 v189, v2, 4, v4
    v_add_u32 v189, 143360, v189
    s_mul_i32 s33, s24, 35840
    v_add_u32 v190, s33, v6
    s_mov_b32 s8, s62
    s_mov_b32 s9, s63
    s_mov_b32 s10, 5242880
    s_mov_b32 s11, 0x20000
    s_cmp_lg_u32 s75, 0
    s_cbranch_scc1 G_DW
    s_waitcnt vmcnt(8)
    s_branch G_DW2
    s_nop 0
G_DW:
    s_waitcnt vmcnt(3)
    s_nop 0
G_DW2:
    s_setprio 3
    v_mov_b32 v237, 1
    v_lshlrev_b32 v238, 7, v1
    s_mov_b64 exec, 15
    buffer_atomic_add v237, v238, s[4:7], s94 offen sc1
    s_mov_b64 exec, -1
    s_setprio 0
    s_cmp_eq_u32 s75, 0
    s_cbranch_scc1 G_NL
    v_mov_b32 v252, 0
    v_lshlrev_b32 v4, 9, v1
    s_mov_b64 exec, 31
    buffer_atomic_add v252, v4, s[4:7], s41 offen sc0 sc1
    s_mov_b64 exec, -1
    s_waitcnt vmcnt(0)
    v_cmp_gt_u32 vcc, 20, v252
    s_nop 0
    s_and_b64 vcc, vcc, 31
    s_mov_b32 s89, 0
    s_nop 1
G_CC_L:
    s_cbranch_vccz G_CC_D
    s_add_u32 s89, s89, 1
    s_cmp_ge_u32 s89, 40000
    s_cbranch_scc1 G_CC_D
    s_sleep 8
    v_mov_b32 v252, 0
    v_lshlrev_b32 v4, 9, v1
    s_mov_b64 exec, 31
    buffer_atomic_add v252, v4, s[4:7], s41 offen sc0 sc1
    s_mov_b64 exec, -1
    s_waitcnt vmcnt(0)
    v_cmp_gt_u32 vcc, 20, v252
    s_nop 0
    s_and_b64 vcc, vcc, 31
    s_nop 1
    s_branch G_CC_L
    s_nop 0
G_CC_D:
    s_add_u32 s96, s73, 0
    buffer_load_dwordx4 v[16:19], v6, s[4:7], s96 offen offset:0 sc1
    buffer_load_dwordx4 v[20:23], v6, s[4:7], s96 offen offset:1024 sc1
    buffer_load_dwordx4 v[24:27], v6, s[4:7], s96 offen offset:2048 sc1
    buffer_load_dwordx4 v[28:31], v6, s[4:7], s96 offen offset:3072 sc1
    s_add_u32 s96, s96, 4096
    buffer_load_dwordx4 v[32:35], v6, s[4:7], s96 offen offset:0 sc1
    s_add_u32 s96, s73, 40960
    buffer_load_dwordx4 v[36:39], v6, s[4:7], s96 offen offset:0 sc1
    buffer_load_dwordx4 v[40:43], v6, s[4:7], s96 offen offset:1024 sc1
    buffer_load_dwordx4 v[44:47], v6, s[4:7], s96 offen offset:2048 sc1
    buffer_load_dwordx4 v[48:51], v6, s[4:7], s96 offen offset:3072 sc1
    s_add_u32 s96, s96, 4096
    buffer_load_dwordx4 v[52:55], v6, s[4:7], s96 offen offset:0 sc1
    s_add_u32 s96, s73, 81920
    buffer_load_dwordx4 v[56:59], v6, s[4:7], s96 offen offset:0 sc1
    buffer_load_dwordx4 v[60:63], v6, s[4:7], s96 offen offset:1024 sc1
    buffer_load_dwordx4 v[64:67], v6, s[4:7], s96 offen offset:2048 sc1
    buffer_load_dwordx4 v[68:71], v6, s[4:7], s96 offen offset:3072 sc1
    s_add_u32 s96, s96, 4096
    buffer_load_dwordx4 v[72:75], v6, s[4:7], s96 offen offset:0 sc1
    s_add_u32 s96, s73, 122880
    buffer_load_dwordx4 v[76:79], v6, s[4:7], s96 offen offset:0 sc1
    buffer_load_dwordx4 v[80:83], v6, s[4:7], s96 offen offset:1024 sc1
    buffer_load_dwordx4 v[84:87], v6, s[4:7], s96 offen offset:2048 sc1
    buffer_load_dwordx4 v[88:91], v6, s[4:7], s96 offen offset:3072 sc1
    s_add_u32 s96, s96, 4096
    buffer_load_dwordx4 v[92:95], v6, s[4:7], s96 offen offset:0 sc1
    s_add_u32 s96, s73, 163840
    buffer_load_dwordx4 v[96:99], v6, s[4:7], s96 offen offset:0 sc1
    buffer_load_dwordx4 v[100:103], v6, s[4:7], s96 offen offset:1024 sc1
    buffer_load_dwordx4 v[104:107], v6, s[4:7], s96 offen offset:2048 sc1
    buffer_load_dwordx4 v[108:111], v6, s[4:7], s96 offen offset:3072 sc1
    s_add_u32 s96, s96, 4096
    buffer_load_dwordx4 v[112:115], v6, s[4:7], s96 offen offset:0 sc1
    s_nop 1
G_NL:
    v_mov_b32 v252, 0
    s_mov_b64 exec, 1
    buffer_atomic_add v252, v10, s[4:7], s54 offen sc0 sc1
    s_mov_b64 exec, -1
    s_waitcnt vmcnt(0)
    v_cmp_gt_u32 vcc, 32, v252
    s_nop 0
    s_and_b64 vcc, vcc, 1
    s_mov_b32 s89, 0
    s_nop 1
G_FH_L:
    s_cbranch_vccz G_FH_D
    s_add_u32 s89, s89, 1
    s_cmp_ge_u32 s89, 40000
    s_cbranch_scc1 G_FH_D
    s_sleep 4
    v_mov_b32 v252, 0
    s_mov_b64 exec, 1
    buffer_atomic_add v252, v10, s[4:7], s54 offen sc0 sc1
    s_mov_b64 exec, -1
    s_waitcnt vmcnt(0)
    v_cmp_gt_u32 vcc, 32, v252
    s_nop 0
    s_and_b64 vcc, vcc, 1
    s_nop 1
    s_branch G_FH_L
    s_nop 0
G_FH_D:
    buffer_load_dwordx4 v[116:119], v236, s[4:7], s36 offen offset:0 sc1
    buffer_load_dwordx4 v[120:123], v236, s[4:7], s36 offen offset:256 sc1
    buffer_load_dwordx4 v[124:127], v236, s[4:7], s36 offen offset:512 sc1
    buffer_load_dwordx4 v[128:131], v236, s[4:7], s36 offen offset:768 sc1
    buffer_load_dwordx4 v[132:135], v236, s[4:7], s36 offen offset:1024 sc1
    buffer_load_dwordx4 v[136:139], v236, s[4:7], s37 offen offset:0 sc1
    buffer_load_dwordx4 v[140:143], v236, s[4:7], s37 offen offset:256 sc1
    buffer_load_dwordx4 v[144:147], v236, s[4:7], s37 offen offset:512 sc1
    buffer_load_dwordx4 v[148:151], v236, s[4:7], s37 offen offset:768 sc1
    buffer_load_dwordx4 v[152:155], v236, s[4:7], s37 offen offset:1024 sc1
    s_waitcnt lgkmcnt(0)
    s_waitcnt vmcnt(9)
    v_mfma_f32_16x16x32_bf16 v[196:199], v[16:19], v[116:119], 0
    v_mfma_f32_16x16x32_bf16 v[200:203], v[36:39], v[116:119], 0
    v_mfma_f32_16x16x32_bf16 v[204:207], v[56:59], v[116:119], 0
    buffer_load_dwordx4 v[156:159], v236, s[4:7], s38 offen offset:0 sc1
    v_mfma_f32_16x16x32_bf16 v[208:211], v[76:79], v[116:119], 0
    v_mfma_f32_16x16x32_bf16 v[212:215], v[96:99], v[116:119], 0
    s_waitcnt vmcnt(9)
    v_mfma_f32_16x16x32_bf16 v[196:199], v[20:23], v[120:123], v[196:199]
    v_mfma_f32_16x16x32_bf16 v[200:203], v[40:43], v[120:123], v[200:203]
    v_mfma_f32_16x16x32_bf16 v[204:207], v[60:63], v[120:123], v[204:207]
    buffer_load_dwordx4 v[160:163], v236, s[4:7], s38 offen offset:256 sc1
    v_mfma_f32_16x16x32_bf16 v[208:211], v[80:83], v[120:123], v[208:211]
    v_mfma_f32_16x16x32_bf16 v[212:215], v[100:103], v[120:123], v[212:215]
    s_waitcnt vmcnt(9)
    v_mfma_f32_16x16x32_bf16 v[196:199], v[24:27], v[124:127], v[196:199]
    v_mfma_f32_16x16x32_bf16 v[200:203], v[44:47], v[124:127], v[200:203]
    v_mfma_f32_16x16x32_bf16 v[204:207], v[64:67], v[124:127], v[204:207]
    buffer_load_dwordx4 v[164:167], v236, s[4:7], s38 offen offset:512 sc1
    v_mfma_f32_16x16x32_bf16 v[208:211], v[84:87], v[124:127], v[208:211]
    v_mfma_f32_16x16x32_bf16 v[212:215], v[104:107], v[124:127], v[212:215]
    s_waitcnt vmcnt(9)
    v_mfma_f32_16x16x32_bf16 v[196:199], v[28:31], v[128:131], v[196:199]
    v_mfma_f32_16x16x32_bf16 v[200:203], v[48:51], v[128:131], v[200:203]
    v_mfma_f32_16x16x32_bf16 v[204:207], v[68:71], v[128:131], v[204:207]
    buffer_load_dwordx4 v[168:171], v236, s[4:7], s38 offen offset:768 sc1
    v_mfma_f32_16x16x32_bf16 v[208:211], v[88:91], v[128:131], v[208:211]
    v_mfma_f32_16x16x32_bf16 v[212:215], v[108:111], v[128:131], v[212:215]
    s_waitcnt vmcnt(9)
    v_mfma_f32_16x16x32_bf16 v[196:199], v[32:35], v[132:135], v[196:199]
    v_mfma_f32_16x16x32_bf16 v[200:203], v[52:55], v[132:135], v[200:203]
    v_mfma_f32_16x16x32_bf16 v[204:207], v[72:75], v[132:135], v[204:207]
    buffer_load_dwordx4 v[172:175], v236, s[4:7], s38 offen offset:1024 sc1
    v_mfma_f32_16x16x32_bf16 v[208:211], v[92:95], v[132:135], v[208:211]
    v_mfma_f32_16x16x32_bf16 v[212:215], v[112:115], v[132:135], v[212:215]
    v_mov_b32 v252, 0
    s_mov_b64 exec, 1
    buffer_atomic_add v252, v10, s[4:7], s55 offen sc0 sc1
    s_mov_b64 exec, -1
    buffer_load_dwordx4 v[116:119], v236, s[4:7], s39 offen offset:0 sc1
    buffer_load_dwordx4 v[120:123], v236, s[4:7], s39 offen offset:256 sc1
    buffer_load_dwordx4 v[124:127], v236, s[4:7], s39 offen offset:512 sc1
    buffer_load_dwordx4 v[128:131], v236, s[4:7], s39 offen offset:768 sc1
    buffer_load_dwordx4 v[132:135], v236, s[4:7], s39 offen offset:1024 sc1
    v_add_u32 v238, s44, v6
    v_add_u32 v239, s45, v6
    s_barrier
    s_waitcnt vmcnt(15)
    v_mfma_f32_16x16x32_bf16 v[216:219], v[16:19], v[136:139], 0
    v_mfma_f32_16x16x32_bf16 v[220:223], v[36:39], v[136:139], 0
    v_mfma_f32_16x16x32_bf16 v[224:227], v[56:59], v[136:139], 0
    ds_write_b128 v238, v[196:199] offset:0
    v_mfma_f32_16x16x32_bf16 v[228:231], v[76:79], v[136:139], 0
    v_mfma_f32_16x16x32_bf16 v[232:235], v[96:99], v[136:139], 0
    s_waitcnt vmcnt(14)
    v_mfma_f32_16x16x32_bf16 v[216:219], v[20:23], v[140:143], v[216:219]
    v_mfma_f32_16x16x32_bf16 v[220:223], v[40:43], v[140:143], v[220:223]
    v_mfma_f32_16x16x32_bf16 v[224:227], v[60:63], v[140:143], v[224:227]
    ds_write_b128 v238, v[200:203] offset:7168
    v_mfma_f32_16x16x32_bf16 v[228:231], v[80:83], v[140:143], v[228:231]
    v_mfma_f32_16x16x32_bf16 v[232:235], v[100:103], v[140:143], v[232:235]
    s_waitcnt vmcnt(13)
    v_mfma_f32_16x16x32_bf16 v[216:219], v[24:27], v[144:147], v[216:219]
    v_mfma_f32_16x16x32_bf16 v[220:223], v[44:47], v[144:147], v[220:223]
    v_mfma_f32_16x16x32_bf16 v[224:227], v[64:67], v[144:147], v[224:227]
    ds_write_b128 v238, v[204:207] offset:14336
    v_mfma_f32_16x16x32_bf16 v[228:231], v[84:87], v[144:147], v[228:231]
    v_mfma_f32_16x16x32_bf16 v[232:235], v[104:107], v[144:147], v[232:235]
    s_waitcnt vmcnt(12)
    v_mfma_f32_16x16x32_bf16 v[216:219], v[28:31], v[148:151], v[216:219]
    v_mfma_f32_16x16x32_bf16 v[220:223], v[48:51], v[148:151], v[220:223]
    v_mfma_f32_16x16x32_bf16 v[224:227], v[68:71], v[148:151], v[224:227]
    ds_write_b128 v239, v[208:211] offset:21504
    v_mfma_f32_16x16x32_bf16 v[228:231], v[88:91], v[148:151], v[228:231]
    v_mfma_f32_16x16x32_bf16 v[232:235], v[108:111], v[148:151], v[232:235]
    s_waitcnt vmcnt(11)
    v_mfma_f32_16x16x32_bf16 v[216:219], v[32:35], v[152:155], v[216:219]
    v_mfma_f32_16x16x32_bf16 v[220:223], v[52:55], v[152:155], v[220:223]
    v_mfma_f32_16x16x32_bf16 v[224:227], v[72:75], v[152:155], v[224:227]
    ds_write_b128 v239, v[212:215] offset:28672
    v_mfma_f32_16x16x32_bf16 v[228:231], v[92:95], v[152:155], v[228:231]
    v_mfma_f32_16x16x32_bf16 v[232:235], v[112:115], v[152:155], v[232:235]
    v_add_u32 v238, s46, v6
    v_add_u32 v239, s47, v6
    s_waitcnt vmcnt(10)
    v_mfma_f32_16x16x32_bf16 v[196:199], v[16:19], v[156:159], 0
    v_mfma_f32_16x16x32_bf16 v[200:203], v[36:39], v[156:159], 0
    v_mfma_f32_16x16x32_bf16 v[204:207], v[56:59], v[156:159], 0
    ds_write_b128 v238, v[216:219] offset:0
    v_mfma_f32_16x16x32_bf16 v[208:211], v[76:79], v[156:159], 0
    v_mfma_f32_16x16x32_bf16 v[212:215], v[96:99], v[156:159], 0
    s_waitcnt vmcnt(9)
    v_mfma_f32_16x16x32_bf16 v[196:199], v[20:23], v[160:163], v[196:199]
    v_mfma_f32_16x16x32_bf16 v[200:203], v[40:43], v[160:163], v[200:203]
    v_mfma_f32_16x16x32_bf16 v[204:207], v[60:63], v[160:163], v[204:207]
    ds_write_b128 v238, v[220:223] offset:7168
    v_mfma_f32_16x16x32_bf16 v[208:211], v[80:83], v[160:163], v[208:211]
    v_mfma_f32_16x16x32_bf16 v[212:215], v[100:103], v[160:163], v[212:215]
    s_waitcnt vmcnt(8)
    v_mfma_f32_16x16x32_bf16 v[196:199], v[24:27], v[164:167], v[196:199]
    v_mfma_f32_16x16x32_bf16 v[200:203], v[44:47], v[164:167], v[200:203]
    v_mfma_f32_16x16x32_bf16 v[204:207], v[64:67], v[164:167], v[204:207]
    ds_write_b128 v238, v[224:227] offset:14336
    v_mfma_f32_16x16x32_bf16 v[208:211], v[84:87], v[164:167], v[208:211]
    v_mfma_f32_16x16x32_bf16 v[212:215], v[104:107], v[164:167], v[212:215]
    s_waitcnt vmcnt(7)
    v_mfma_f32_16x16x32_bf16 v[196:199], v[28:31], v[168:171], v[196:199]
    v_mfma_f32_16x16x32_bf16 v[200:203], v[48:51], v[168:171], v[200:203]
    v_mfma_f32_16x16x32_bf16 v[204:207], v[68:71], v[168:171], v[204:207]
    ds_write_b128 v239, v[228:231] offset:21504
    v_mfma_f32_16x16x32_bf16 v[208:211], v[88:91], v[168:171], v[208:211]
    v_mfma_f32_16x16x32_bf16 v[212:215], v[108:111], v[168:171], v[212:215]
    s_waitcnt vmcnt(6)
    v_mfma_f32_16x16x32_bf16 v[196:199], v[32:35], v[172:175], v[196:199]
    v_mfma_f32_16x16x32_bf16 v[200:203], v[52:55], v[172:175], v[200:203]
    v_mfma_f32_16x16x32_bf16 v[204:207], v[72:75], v[172:175], v[204:207]
    ds_write_b128 v239, v[232:235] offset:28672
    v_mfma_f32_16x16x32_bf16 v[208:211], v[92:95], v[172:175], v[208:211]
    v_mfma_f32_16x16x32_bf16 v[212:215], v[112:115], v[172:175], v[212:215]
    s_waitcnt vmcnt(5)
    v_cmp_gt_u32 vcc, s56, v252
    s_nop 0
    s_and_b64 vcc, vcc, 1
    s_mov_b32 s89, 0
    s_nop 2
G_FP_L:
    s_cbranch_vccz G_FP_D
    s_add_u32 s89, s89, 1
    s_cmp_ge_u32 s89, 40000
    s_cbranch_scc1 G_FP_D
    s_sleep 2
    v_mov_b32 v252, 0
    s_mov_b64 exec, 1
    buffer_atomic_add v252, v10, s[4:7], s55 offen sc0 sc1
    s_mov_b64 exec, -1
    s_waitcnt vmcnt(0)
    v_cmp_gt_u32 vcc, s56, v252
    s_nop 0
    s_and_b64 vcc, vcc, 1
    s_nop 1
    s_branch G_FP_L
    s_nop 0
G_FP_D:
    s_add_u32 s32, s52, 0
    buffer_load_dword v12, v0, s[4:7], s32 offen sc1
    s_add_u32 s32, s52, 16384
    buffer_load_dword v13, v0, s[4:7], s32 offen sc1
    s_add_u32 s32, s52, 32768
    buffer_load_dword v7, v0, s[4:7], s32 offen sc1
    s_add_u32 s32, s52, 49152
    buffer_load_dword v8, v0, s[4:7], s32 offen sc1
    s_add_u32 s32, s52, 65536
    buffer_load_dword v9, v0, s[4:7], s32 offen sc1
    s_add_u32 s32, s52, 2621440
    s_cmp_eq_u32 s42, 0
    s_cselect_b32 s32, s32, 1073741824
    buffer_load_dword v237, v195, s[4:7], s32 offen sc1
    s_lshl_b32 s32, s53, 3
    s_add_u32 s32, s32, 12148736
    buffer_load_dwordx2 v[14:15], v255, s[4:7], s32 offen sc1
    v_add_u32 v238, s48, v6
    v_add_u32 v239, s49, v6
    ds_write_b128 v238, v[196:199] offset:0
    ds_write_b128 v238, v[200:203] offset:7168
    ds_write_b128 v238, v[204:207] offset:14336
    ds_write_b128 v239, v[208:211] offset:21504
    ds_write_b128 v239, v[212:215] offset:28672
    v_lshlrev_b32 v216, 16, v240
    v_and_b32 v217, 0xffff0000, v240
    v_lshlrev_b32 v218, 16, v246
    v_and_b32 v219, 0xffff0000, v246
    v_pk_mul_f32 v[164:165], v[216:217], v[218:219]
    v_lshlrev_b32 v216, 16, v241
    v_and_b32 v217, 0xffff0000, v241
    v_lshlrev_b32 v218, 16, v247
    v_and_b32 v219, 0xffff0000, v247
    v_pk_mul_f32 v[166:167], v[216:217], v[218:219]
    v_lshlrev_b32 v216, 16, v242
    v_and_b32 v217, 0xffff0000, v242
    v_lshlrev_b32 v218, 16, v248
    v_and_b32 v219, 0xffff0000, v248
    v_pk_mul_f32 v[168:169], v[216:217], v[218:219]
    v_lshlrev_b32 v216, 16, v243
    v_and_b32 v217, 0xffff0000, v243
    v_lshlrev_b32 v218, 16, v249
    v_and_b32 v219, 0xffff0000, v249
    v_pk_mul_f32 v[170:171], v[216:217], v[218:219]
    v_lshlrev_b32 v216, 16, v244
    v_and_b32 v217, 0xffff0000, v244
    v_lshlrev_b32 v218, 16, v250
    v_and_b32 v219, 0xffff0000, v250
    v_pk_mul_f32 v[172:173], v[216:217], v[218:219]
    v_lshlrev_b32 v216, 16, v245
    v_and_b32 v217, 0xffff0000, v245
    v_lshlrev_b32 v218, 16, v251
    v_and_b32 v219, 0xffff0000, v251
    v_pk_mul_f32 v[174:175], v[216:217], v[218:219]
    v_add_u32 v238, s50, v6
    v_add_u32 v239, s51, v6
    s_waitcnt lgkmcnt(0)
    s_barrier
    ds_read_b128 v[136:139], v190 offset:0
    ds_read_b128 v[140:143], v190 offset:1024
    ds_read_b128 v[144:147], v190 offset:2048
    ds_read_b128 v[148:151], v190 offset:4096
    ds_read_b128 v[152:155], v190 offset:5120
    ds_read_b128 v[156:159], v190 offset:6144
    ds_read_b128 v[196:199], v190 offset:7168
    ds_read_b128 v[200:203], v190 offset:8192
    ds_read_b128 v[204:207], v190 offset:9216
    ds_read_b128 v[208:211], v190 offset:11264
    ds_read_b128 v[212:215], v190 offset:12288
    ds_read_b128 v[216:219], v190 offset:13312
    s_waitcnt lgkmcnt(6)
    v_pk_add_f32 v[136:137], v[136:137], v[140:141]
    v_pk_add_f32 v[144:145], v[144:145], v[148:149]
    v_pk_add_f32 v[152:153], v[152:153], v[156:157]
    v_pk_add_f32 v[138:139], v[138:139], v[142:143]
    v_pk_add_f32 v[146:147], v[146:147], v[150:151]
    v_pk_add_f32 v[154:155], v[154:155], v[158:159]
    v_pk_add_f32 v[136:137], v[136:137], v[144:145]
    v_pk_add_f32 v[164:165], v[164:165], v[152:153]
    v_pk_add_f32 v[138:139], v[138:139], v[146:147]
    v_pk_add_f32 v[166:167], v[166:167], v[154:155]
    v_pk_add_f32 v[164:165], v[164:165], v[136:137]
    v_pk_add_f32 v[166:167], v[166:167], v[138:139]
    ds_read_b128 v[136:139], v190 offset:14336
    ds_read_b128 v[140:143], v190 offset:15360
    ds_read_b128 v[144:147], v190 offset:16384
    ds_read_b128 v[148:151], v190 offset:18432
    ds_read_b128 v[152:155], v190 offset:19456
    ds_read_b128 v[156:159], v190 offset:20480
    s_waitcnt lgkmcnt(6)
    v_pk_add_f32 v[196:197], v[196:197], v[200:201]
    v_pk_add_f32 v[204:205], v[204:205], v[208:209]
    v_pk_add_f32 v[212:213], v[212:213], v[216:217]
    v_pk_add_f32 v[198:199], v[198:199], v[202:203]
    v_pk_add_f32 v[206:207], v[206:207], v[210:211]
    v_pk_add_f32 v[214:215], v[214:215], v[218:219]
    v_pk_add_f32 v[196:197], v[196:197], v[204:205]
    v_pk_add_f32 v[168:169], v[168:169], v[212:213]
    v_pk_add_f32 v[198:199], v[198:199], v[206:207]
    v_pk_add_f32 v[170:171], v[170:171], v[214:215]
    v_pk_add_f32 v[168:169], v[168:169], v[196:197]
    v_pk_add_f32 v[170:171], v[170:171], v[198:199]
    s_waitcnt lgkmcnt(0)
    v_pk_add_f32 v[136:137], v[136:137], v[140:141]
    v_pk_add_f32 v[144:145], v[144:145], v[148:149]
    v_pk_add_f32 v[152:153], v[152:153], v[156:157]
    v_pk_add_f32 v[138:139], v[138:139], v[142:143]
    v_pk_add_f32 v[146:147], v[146:147], v[150:151]
    v_pk_add_f32 v[154:155], v[154:155], v[158:159]
    v_pk_add_f32 v[136:137], v[136:137], v[144:145]
    v_pk_add_f32 v[172:173], v[172:173], v[152:153]
    v_pk_add_f32 v[138:139], v[138:139], v[146:147]
    v_pk_add_f32 v[174:175], v[174:175], v[154:155]
    v_pk_add_f32 v[172:173], v[172:173], v[136:137]
    v_pk_add_f32 v[174:175], v[174:175], v[138:139]
    s_waitcnt vmcnt(11)
    v_mfma_f32_16x16x32_bf16 v[228:231], v[76:79], v[116:119], 0
    v_mfma_f32_16x16x32_bf16 v[232:235], v[96:99], v[116:119], 0
    v_mfma_f32_16x16x32_bf16 v[216:219], v[16:19], v[116:119], v[164:167]
    v_mfma_f32_16x16x32_bf16 v[220:223], v[36:39], v[116:119], v[168:171]
    v_mfma_f32_16x16x32_bf16 v[224:227], v[56:59], v[116:119], v[172:175]
    s_waitcnt vmcnt(10)
    v_mfma_f32_16x16x32_bf16 v[228:231], v[80:83], v[120:123], v[228:231]
    v_mfma_f32_16x16x32_bf16 v[232:235], v[100:103], v[120:123], v[232:235]
    v_mfma_f32_16x16x32_bf16 v[216:219], v[20:23], v[120:123], v[216:219]
    v_mfma_f32_16x16x32_bf16 v[220:223], v[40:43], v[120:123], v[220:223]
    v_mfma_f32_16x16x32_bf16 v[224:227], v[60:63], v[120:123], v[224:227]
    s_waitcnt vmcnt(9)
    v_mfma_f32_16x16x32_bf16 v[228:231], v[84:87], v[124:127], v[228:231]
    v_mfma_f32_16x16x32_bf16 v[232:235], v[104:107], v[124:127], v[232:235]
    v_mfma_f32_16x16x32_bf16 v[216:219], v[24:27], v[124:127], v[216:219]
    v_mfma_f32_16x16x32_bf16 v[220:223], v[44:47], v[124:127], v[220:223]
    v_mfma_f32_16x16x32_bf16 v[224:227], v[64:67], v[124:127], v[224:227]
    s_waitcnt vmcnt(8)
    v_mfma_f32_16x16x32_bf16 v[228:231], v[88:91], v[128:131], v[228:231]
    v_mfma_f32_16x16x32_bf16 v[232:235], v[108:111], v[128:131], v[232:235]
    v_mfma_f32_16x16x32_bf16 v[216:219], v[28:31], v[128:131], v[216:219]
    v_mfma_f32_16x16x32_bf16 v[220:223], v[48:51], v[128:131], v[220:223]
    v_mfma_f32_16x16x32_bf16 v[224:227], v[68:71], v[128:131], v[224:227]
    s_waitcnt vmcnt(7)
    v_mfma_f32_16x16x32_bf16 v[228:231], v[92:95], v[132:135], v[228:231]
    v_mfma_f32_16x16x32_bf16 v[232:235], v[112:115], v[132:135], v[232:235]
    v_mfma_f32_16x16x32_bf16 v[216:219], v[32:35], v[132:135], v[216:219]
    v_mfma_f32_16x16x32_bf16 v[220:223], v[52:55], v[132:135], v[220:223]
    v_mfma_f32_16x16x32_bf16 v[224:227], v[72:75], v[132:135], v[224:227]
    s_waitcnt vmcnt(0)
    s_nop 2
    ds_write_b128 v239, v[228:231] offset:21504
    ds_write_b128 v239, v[232:235] offset:28672
    v_lshlrev_b32 v136, 16, v12
    v_and_b32 v137, 0xffff0000, v12
    v_lshlrev_b32 v138, 16, v13
    v_and_b32 v139, 0xffff0000, v13
    v_lshlrev_b32 v140, 16, v7
    v_and_b32 v141, 0xffff0000, v7
    v_lshlrev_b32 v142, 16, v8
    v_and_b32 v143, 0xffff0000, v8
    v_lshlrev_b32 v144, 16, v9
    v_and_b32 v145, 0xffff0000, v9
    v_pk_add_f32 v[146:147], v[138:139], v[144:145]
    v_pk_add_f32 v[148:149], v[138:139], v[144:145] neg_lo:[0,1] neg_hi:[0,1]
    v_pk_add_f32 v[150:151], v[140:141], v[142:143]
    v_pk_add_f32 v[152:153], v[140:141], v[142:143] neg_lo:[0,1] neg_hi:[0,1]
    s_cmp_lg_u32 s24, 0
    s_nop 2
    s_cbranch_scc1 G_NSP3
    s_mov_b64 exec, 0xffff
    v_lshlrev_b32 v137, 16, v237
    v_add_f32 v146, v138, v138
    v_add_f32 v147, v144, v144
    v_add_f32 v148, v145, v145
    v_add_f32 v149, v139, v139
    v_add_f32 v150, v140, v140
    v_add_f32 v151, v142, v142
    v_add_f32 v152, v143, v143
    v_add_f32 v153, v141, v141
    s_mov_b64 exec, -1
    s_nop 3
G_NSP3:
    v_pk_add_f32 v[162:163], v[136:137], v[146:147]
    v_pk_fma_f32 v[154:155], v[146:147], s[78:79], v[136:137]
    v_pk_fma_f32 v[156:157], v[146:147], s[80:81], v[136:137]
    v_pk_mul_f32 v[158:159], v[148:149], s[82:83]
    v_pk_mul_f32 v[160:161], v[148:149], s[84:85]
    v_pk_add_f32 v[162:163], v[162:163], v[150:151]
    v_pk_fma_f32 v[154:155], v[150:151], s[80:81], v[154:155]
    v_pk_fma_f32 v[156:157], v[150:151], s[78:79], v[156:157]
    v_pk_fma_f32 v[158:159], v[152:153], s[84:85], v[158:159]
    v_pk_fma_f32 v[160:161], v[152:153], s[82:83], v[160:161] neg_lo:[1,0,0] neg_hi:[1,0,0]
    v_sub_f32 v146, v154, v159
    v_add_f32 v147, v155, v158
    v_add_f32 v148, v154, v159
    v_sub_f32 v149, v155, v158
    v_sub_f32 v150, v156, v161
    v_add_f32 v151, v157, v160
    v_add_f32 v152, v156, v161
    v_sub_f32 v153, v157, v160
    v_cvt_pk_bf16_f32 v136, v162, v163
    ds_write_b32 v184, v136
    v_cvt_pk_bf16_f32 v138, v146, v147
    ds_write_b32 v185, v138
    v_cvt_pk_bf16_f32 v140, v150, v151
    ds_write_b32 v186, v140
    v_cvt_pk_bf16_f32 v142, v152, v153
    ds_write_b32 v187, v142
    v_cvt_pk_bf16_f32 v144, v148, v149
    ds_write_b32 v188, v144
    v_cmp_ne_u32 vcc, s43, v15
    s_mov_b32 s89, 0
    s_nop 3
G_GT_L:
    s_cbranch_vccz G_GT_D
    s_add_u32 s89, s89, 1
    s_cmp_ge_u32 s89, 40000
    s_cbranch_scc1 G_GT_D
    s_sleep 2
    s_lshl_b32 s32, s53, 3
    s_add_u32 s32, s32, 12148736
    buffer_load_dwordx2 v[14:15], v255, s[4:7], s32 offen sc1
    s_waitcnt vmcnt(0)
    v_cmp_ne_u32 vcc, s43, v15
    s_nop 3
    s_branch G_GT_L
    s_nop 0
G_GT_D:
    v_mul_f32 v192, 0x35cccccd, v14
    v_sub_f32 v194, 1.0, v14
    s_mul_i32 s32, s53, 2560
    s_lshl_b32 s33, s28, 6
    s_add_u32 s32, s32, s33
    s_waitcnt lgkmcnt(0)
    s_barrier
    ds_read_b128 v[136:139], v189 offset:0
    ds_read_b128 v[140:143], v189 offset:64
    ds_read_b128 v[144:147], v189 offset:2304
    ds_read_b128 v[148:151], v189 offset:2368
    ds_read_b128 v[152:155], v189 offset:4608
    ds_read_b128 v[156:159], v189 offset:4672
    ds_read_b128 v[196:199], v190 offset:3072
    ds_read_b128 v[200:203], v190 offset:10240
    ds_read_b128 v[204:207], v190 offset:17408
    s_waitcnt lgkmcnt(3)
    v_mfma_f32_16x16x32_bf16 v[240:243], v[136:139], v[176:179], 0
    v_mfma_f32_16x16x32_bf16 v[244:247], v[144:147], v[176:179], 0
    v_mfma_f32_16x16x32_bf16 v[248:251], v[152:155], v[176:179], 0
    v_mfma_f32_16x16x32_bf16 v[240:243], v[140:143], v[180:183], v[240:243]
    v_mfma_f32_16x16x32_bf16 v[244:247], v[148:151], v[180:183], v[244:247]
    v_mfma_f32_16x16x32_bf16 v[248:251], v[156:159], v[180:183], v[248:251]
    s_nop 5
    v_pk_mul_f32 v[240:241], v[240:241], v[192:193] op_sel_hi:[1,0]
    v_pk_mul_f32 v[242:243], v[242:243], v[192:193] op_sel_hi:[1,0]
    v_pk_mul_f32 v[244:245], v[244:245], v[192:193] op_sel_hi:[1,0]
    v_pk_mul_f32 v[246:247], v[246:247], v[192:193] op_sel_hi:[1,0]
    v_pk_mul_f32 v[248:249], v[248:249], v[192:193] op_sel_hi:[1,0]
    v_pk_mul_f32 v[250:251], v[250:251], v[192:193] op_sel_hi:[1,0]
    s_waitcnt lgkmcnt(2)
    v_pk_add_f32 v[216:217], v[216:217], v[196:197]
    v_pk_add_f32 v[218:219], v[218:219], v[198:199]
    v_pk_fma_f32 v[216:217], v[216:217], v[194:195], v[240:241] op_sel_hi:[1,0,1]
    v_pk_fma_f32 v[218:219], v[218:219], v[194:195], v[242:243] op_sel_hi:[1,0,1]
    buffer_store_dwordx4 v[216:219], v191, s[8:11], s32 offen offset:0
    s_waitcnt lgkmcnt(1)
    v_pk_add_f32 v[220:221], v[220:221], v[200:201]
    v_pk_add_f32 v[222:223], v[222:223], v[202:203]
    v_pk_fma_f32 v[220:221], v[220:221], v[194:195], v[244:245] op_sel_hi:[1,0,1]
    v_pk_fma_f32 v[222:223], v[222:223], v[194:195], v[246:247] op_sel_hi:[1,0,1]
    buffer_store_dwordx4 v[220:223], v191, s[8:11], s32 offen offset:512
    s_waitcnt lgkmcnt(0)
    v_pk_add_f32 v[224:225], v[224:225], v[204:205]
    v_pk_add_f32 v[226:227], v[226:227], v[206:207]
    v_pk_fma_f32 v[224:225], v[224:225], v[194:195], v[248:249] op_sel_hi:[1,0,1]
    v_pk_fma_f32 v[226:227], v[226:227], v[194:195], v[250:251] op_sel_hi:[1,0,1]
    buffer_store_dwordx4 v[224:227], v191, s[8:11], s32 offen offset:1024
    s_endpgm
    s_nop 2
W_F:
    s_lshr_b32 s91, s24, 1
    s_and_b32 s92, s24, 1
    s_mul_i32 s93, s27, 1280
    s_mul_i32 s33, s92, 1310720
    s_add_u32 s93, s93, s33
    s_lshl_b32 s33, s91, 8
    s_add_u32 s93, s93, s33
    s_lshl_b32 s33, s28, 5
    s_add_u32 s93, s93, s33
    s_lshl_b32 s94, s24, 10
    s_add_u32 s94, s94, 151552
    s_mov_b32 s33, 40960
    v_lshrrev_b32 v4, 1, v1
    v_and_b32 v160, 1, v1
    v_lshlrev_b32 v160, 4, v160
    v_mad_u32_u24 v160, v4, s33, v160
    s_min_u32 s33, s2, 199
    s_mul_i32 s95, s33, 205
    s_lshr_b32 s95, s95, 10
    s_mul_i32 s34, s95, 5
    s_sub_u32 s96, s33, s34
    s_lshl_b32 s96, s96, 2
    s_add_u32 s96, s96, s24
    v_and_b32 v161, 7, v3
    v_lshl_add_u32 v161, v2, 3, v161
    s_lshl_b32 s33, s96, 5
    v_add_lshl_u32 v161, s33, v161, 1
    v_mul_u32_u24 v162, 1280, v3
    v_lshl_add_u32 v162, v2, 4, v162
    s_mul_i32 s33, s95, 20480
    s_lshl_b32 s34, s96, 6
    s_add_u32 s33, s33, s34
    v_add_u32 v162, s33, v162
    v_mov_b32 v163, 0
    s_waitcnt lgkmcnt(0)
    s_mov_b32 s42, s3
    s_mov_b32 s4, s66
    s_mov_b32 s5, s67
    s_mov_b32 s6, 268435456
    s_mov_b32 s7, 0x20000
    s_mov_b32 s8, s36
    s_mov_b32 s9, s37
    s_mov_b32 s10, 2621440
    s_mov_b32 s11, 0x20000
    s_cmp_lg_u32 s24, 3
    s_cbranch_scc1 F_NZ
    s_cmp_ge_u32 s2, 8
    s_cbranch_scc1 F_NZ
    v_lshlrev_b32 v4, 7, v1
    s_lshl_b32 s32, s2, 13
    s_add_u32 s32, s32, 12337152
    buffer_store_dword v163, v4, s[4:7], s32 offen sc0 sc1
    s_cmp_lg_u32 s2, 0
    s_cbranch_scc1 F_NZ
    s_memrealtime s[86:87]
    s_waitcnt lgkmcnt(0)
    s_or_b32 s33, s86, 1
    v_mov_b32 v4, s33
    global_store_dword v163, v4, s[64:65] sc0 sc1
    s_nop 3
F_NZ:
    s_cmp_ge_u32 s24, 2
    s_cbranch_scc1 F_A2
    s_add_u32 m0, s94, 8192
    s_add_u32 s32, s93, 1024
    buffer_load_dwordx4 v160, s[8:11], s32 offen lds
    s_nop 1
F_A2:
    s_mov_b32 m0, s94
    s_add_u32 s32, s93, 512
    buffer_load_dwordx4 v160, s[8:11], s93 offen lds
    s_add_u32 m0, s94, 4096
    s_nop 0
    buffer_load_dwordx4 v160, s[8:11], s32 offen lds
    s_setprio 3
    s_cmp_lg_u32 s24, 2
    s_cbranch_scc1 F_NPF
    s_getpc_b64 s[90:91]
    F_PC:
    s_sub_u32 s90, s90, F_PC-gated_mix__spectral_gfnet__ssm_conv_s5__prompt_kernel
    s_subb_u32 s91, s91, 0
    s_lshl_b32 s33, s35, 4
    v_add_lshl_u32 v4, s33, v3, 7
    s_mov_b32 s33, W_END-gated_mix__spectral_gfnet__ssm_conv_s5__prompt_kernel
    v_min_u32 v4, s33, v4
    global_load_dword v177, v4, s[90:91]
    s_nop 3
F_NPF:
    s_barrier
    global_load_ushort v164, v161, s[44:45]
    global_load_ushort v165, v161, s[46:47]
    global_load_ushort v166, v161, s[56:57]
    global_load_dwordx4 v[168:171], v162, s[52:53]
    global_load_dwordx4 v[172:175], v162, s[54:55]
    v_lshlrev_b32 v4, 3, v2
    s_lshl_b32 s33, s28, 5
    v_add_u32 v4, s33, v4
    global_load_dwordx2 v[246:247], v4, s[58:59] offset:768
    global_load_dwordx2 v[248:249], v4, s[58:59] offset:1024
    s_setprio 0
    s_mul_i32 s33, s35, 52
    s_lshr_b32 s33, s33, 8
    s_mul_i32 s34, s33, 5
    s_sub_u32 s30, s35, s34
    s_and_b32 s29, s2, 7
    s_lshl_b32 s33, s33, 3
    s_add_u32 s29, s29, s33
    s_mul_i32 s31, s29, 5
    s_add_u32 s31, s31, s30
    s_sub_u32 s33, s31, 3
    s_cmp_lt_u32 s33, 2
    s_cselect_b32 s29, 32, s29
    s_cmp_le_u32 s2, 160
    s_cselect_b32 s77, 1, 0
    v_lshrrev_b32 v4, 1, v3
    s_lshl_b32 s33, s24, 3
    v_add_u32 v208, s33, v4
    v_and_b32 v5, 1, v3
    v_cvt_f32_u32 v209, v5
    v_mul_f32 v209, 0x3e800000, v209
    v_lshl_add_u32 v5, v208, 1, v5
    v_cmp_eq_u32 vcc, 1, v5
    s_nop 1
    v_cndmask_b32 v208, v208, 32, vcc
    v_cndmask_b32 v209, v209, 0, vcc
    v_cvt_f32_u32 v208, v208
    v_mul_f32 v208, 0x3c800000, v208
    v_cvt_f32_u32 v5, v2
    v_mul_f32 v5, 4.0, v5
    v_fmac_f32 v209, v208, v5
    v_fmamk_f32 v188, v208, 0x00000000, v209
    v_fmamk_f32 v189, v208, 0x3f800000, v209
    v_fmamk_f32 v190, v208, 0x40000000, v209
    v_fmamk_f32 v191, v208, 0x40400000, v209
    v_fmamk_f32 v192, v208, 0x41800000, v209
    v_fmamk_f32 v193, v208, 0x41880000, v209
    v_fmamk_f32 v194, v208, 0x41900000, v209
    v_fmamk_f32 v195, v208, 0x41980000, v209
    v_fmamk_f32 v196, v208, 0x42000000, v209
    v_fmamk_f32 v197, v208, 0x42040000, v209
    v_fmamk_f32 v198, v208, 0x42080000, v209
    v_fmamk_f32 v199, v208, 0x420c0000, v209
    v_fmamk_f32 v200, v208, 0x42400000, v209
    v_fmamk_f32 v201, v208, 0x42440000, v209
    v_fmamk_f32 v202, v208, 0x42480000, v209
    v_fmamk_f32 v203, v208, 0x424c0000, v209
    v_cos_f32 v188, v188
    v_cos_f32 v189, v189
    v_cos_f32 v190, v190
    v_cos_f32 v191, v191
    v_cos_f32 v192, v192
    v_cos_f32 v193, v193
    v_cos_f32 v194, v194
    v_cos_f32 v195, v195
    v_cos_f32 v196, v196
    v_cos_f32 v197, v197
    v_cos_f32 v198, v198
    v_cos_f32 v199, v199
    v_cos_f32 v200, v200
    v_cos_f32 v201, v201
    v_cos_f32 v202, v202
    v_cos_f32 v203, v203
    v_cvt_pk_bf16_f32 v180, v188, v189
    v_cvt_pk_bf16_f32 v181, v190, v191
    v_cvt_pk_bf16_f32 v182, v192, v193
    v_cvt_pk_bf16_f32 v183, v194, v195
    v_cvt_pk_bf16_f32 v184, v196, v197
    v_cvt_pk_bf16_f32 v185, v198, v199
    v_cvt_pk_bf16_f32 v186, v200, v201
    v_cvt_pk_bf16_f32 v187, v202, v203
    s_lshl_b32 s33, s28, 4
    v_add_u32 v5, s33, v3
    v_cvt_f32_u32 v5, v5
    v_mul_f32 v204, 0x3e4ccccd, v5
    v_mul_f32 v206, 0x3ecccccd, v5
    v_sin_f32 v205, v204
    v_sin_f32 v207, v206
    v_cos_f32 v204, v204
    v_cos_f32 v206, v206
    v_and_b32 v5, 1, v3
    v_cmp_eq_u32 vcc, 1, v5
    v_mov_b32 v210, 0x05040100
    v_mov_b32 v4, 0x03020706
    v_cndmask_b32 v210, v210, v4, vcc
    v_mul_u32_u24 v211, 10, v2
    v_lshlrev_b32 v211, 14, v211
    v_lshl_add_u32 v211, v5, 5, v211
    v_bfe_u32 v4, v3, 2, 1
    v_lshl_add_u32 v211, v4, 4, v211
    v_lshrrev_b32 v4, 3, v3
    v_lshl_add_u32 v211, v4, 3, v211
    v_and_b32 v4, 2, v3
    v_lshl_add_u32 v211, v4, 1, v211
    s_mul_i32 s93, s24, 655360
    s_lshl_b32 s33, s28, 11
    s_add_u32 s93, s93, s33
    s_lshl_b32 s33, s27, 6
    s_add_u32 s93, s93, s33
    v_lshlrev_b32 v212, 3, v1
    v_add_u32 v212, 151552, v212
    s_lshl_b32 s33, s24, 5
    v_add_u32 v250, s33, v7
    v_cvt_f32_u32 v251, v250
    v_mul_f32 v251, 0x3c000000, v251
    v_cvt_f32_u32 v245, v8
    v_mul_f32 v245, 4.0, v245
    v_mul_f32 v255, v251, v245
    v_fmamk_f32 v216, v251, 0x00000000, v255
    v_fmamk_f32 v217, v251, 0x3f800000, v255
    v_fmamk_f32 v218, v251, 0x40000000, v255
    v_fmamk_f32 v219, v251, 0x40400000, v255
    v_fmamk_f32 v220, v251, 0x41000000, v255
    v_fmamk_f32 v221, v251, 0x41100000, v255
    v_fmamk_f32 v222, v251, 0x41200000, v255
    v_fmamk_f32 v223, v251, 0x41300000, v255
    v_cos_f32 v224, v216
    v_cos_f32 v225, v217
    v_cos_f32 v226, v218
    v_cos_f32 v227, v219
    v_cos_f32 v228, v220
    v_cos_f32 v229, v221
    v_cos_f32 v230, v222
    v_cos_f32 v231, v223
    v_sin_f32 v216, v216
    v_sin_f32 v217, v217
    v_sin_f32 v218, v218
    v_sin_f32 v219, v219
    v_sin_f32 v220, v220
    v_sin_f32 v221, v221
    v_sin_f32 v222, v222
    v_sin_f32 v223, v223
    v_cvt_pk_bf16_f32 v16, v224, v225
    v_cvt_pk_bf16_f32 v17, v226, v227
    v_cvt_pk_bf16_f32 v18, v228, v229
    v_cvt_pk_bf16_f32 v19, v230, v231
    v_cvt_pk_bf16_f32 v48, v216, v217
    v_cvt_pk_bf16_f32 v49, v218, v219
    v_cvt_pk_bf16_f32 v50, v220, v221
    v_cvt_pk_bf16_f32 v51, v222, v223
    v_fmamk_f32 v216, v251, 0x41800000, v255
    v_fmamk_f32 v217, v251, 0x41880000, v255
    v_fmamk_f32 v218, v251, 0x41900000, v255
    v_fmamk_f32 v219, v251, 0x41980000, v255
    v_fmamk_f32 v220, v251, 0x41c00000, v255
    v_fmamk_f32 v221, v251, 0x41c80000, v255
    v_fmamk_f32 v222, v251, 0x41d00000, v255
    v_fmamk_f32 v223, v251, 0x41d80000, v255
    v_cos_f32 v224, v216
    v_cos_f32 v225, v217
    v_cos_f32 v226, v218
    v_cos_f32 v227, v219
    v_cos_f32 v228, v220
    v_cos_f32 v229, v221
    v_cos_f32 v230, v222
    v_cos_f32 v231, v223
    v_sin_f32 v216, v216
    v_sin_f32 v217, v217
    v_sin_f32 v218, v218
    v_sin_f32 v219, v219
    v_sin_f32 v220, v220
    v_sin_f32 v221, v221
    v_sin_f32 v222, v222
    v_sin_f32 v223, v223
    v_cvt_pk_bf16_f32 v20, v224, v225
    v_cvt_pk_bf16_f32 v21, v226, v227
    v_cvt_pk_bf16_f32 v22, v228, v229
    v_cvt_pk_bf16_f32 v23, v230, v231
    v_cvt_pk_bf16_f32 v52, v216, v217
    v_cvt_pk_bf16_f32 v53, v218, v219
    v_cvt_pk_bf16_f32 v54, v220, v221
    v_cvt_pk_bf16_f32 v55, v222, v223
    v_bfe_i32 v216, v250, 0, 1
    v_and_b32 v219, 0x80008000, v216
    v_bfe_i32 v218, v250, 1, 1
    v_and_b32 v218, 0x80008000, v218
    v_xor_b32 v217, v218, v219
    v_bfi_b32 v24, v216, v48, v16
    v_bfi_b32 v56, v216, v16, v48
    v_bfi_b32 v25, v216, v49, v17
    v_bfi_b32 v57, v216, v17, v49
    v_bfi_b32 v26, v216, v50, v18
    v_bfi_b32 v58, v216, v18, v50
    v_bfi_b32 v27, v216, v51, v19
    v_bfi_b32 v59, v216, v19, v51
    v_bfi_b32 v28, v216, v52, v20
    v_bfi_b32 v60, v216, v20, v52
    v_bfi_b32 v29, v216, v53, v21
    v_bfi_b32 v61, v216, v21, v53
    v_bfi_b32 v30, v216, v54, v22
    v_bfi_b32 v62, v216, v22, v54
    v_bfi_b32 v31, v216, v55, v23
    v_bfi_b32 v63, v216, v23, v55
    v_xor_b32 v24, v217, v24
    v_xor_b32 v56, v218, v56
    v_xor_b32 v25, v217, v25
    v_xor_b32 v57, v218, v57
    v_xor_b32 v26, v217, v26
    v_xor_b32 v58, v218, v58
    v_xor_b32 v27, v217, v27
    v_xor_b32 v59, v218, v59
    v_xor_b32 v28, v217, v28
    v_xor_b32 v60, v218, v60
    v_xor_b32 v29, v217, v29
    v_xor_b32 v61, v218, v61
    v_xor_b32 v30, v217, v30
    v_xor_b32 v62, v218, v62
    v_xor_b32 v31, v217, v31
    v_xor_b32 v63, v218, v63
    v_xor_b32 v32, v219, v16
    v_xor_b32 v64, v219, v48
    v_xor_b32 v33, v219, v17
    v_xor_b32 v65, v219, v49
    v_xor_b32 v34, v219, v18
    v_xor_b32 v66, v219, v50
    v_xor_b32 v35, v219, v19
    v_xor_b32 v67, v219, v51
    v_xor_b32 v36, v219, v20
    v_xor_b32 v68, v219, v52
    v_xor_b32 v37, v219, v21
    v_xor_b32 v69, v219, v53
    v_xor_b32 v38, v219, v22
    v_xor_b32 v70, v219, v54
    v_xor_b32 v39, v219, v23
    v_xor_b32 v71, v219, v55
    v_xor_b32 v40, v219, v24
    v_xor_b32 v72, v219, v56
    v_xor_b32 v41, v219, v25
    v_xor_b32 v73, v219, v57
    v_xor_b32 v42, v219, v26
    v_xor_b32 v74, v219, v58
    v_xor_b32 v43, v219, v27
    v_xor_b32 v75, v219, v59
    v_xor_b32 v44, v219, v28
    v_xor_b32 v76, v219, v60
    v_xor_b32 v45, v219, v29
    v_xor_b32 v77, v219, v61
    v_xor_b32 v46, v219, v30
    v_xor_b32 v78, v219, v62
    v_xor_b32 v47, v219, v31
    v_xor_b32 v79, v219, v63
    s_waitcnt vmcnt(7)
    v_mov_b32 v236, 1
    ds_write_b32 v9, v236
    s_cmp_lg_u32 s24, 3
    s_nop 1
    s_cbranch_scc1 F_NP
    s_cmp_ge_u32 s2, 8
    s_cbranch_scc1 F_NP
    v_mov_b32 v4, 1
    s_mov_b64 exec, 1
    s_setprio 3
    global_atomic_add v163, v4, s[64:65] offset:4 sc1
    s_mov_b64 exec, -1
    s_setprio 0
    s_nop 0
F_NP:
    ds_read_b128 v[236:239], v11 offset:16
    s_waitcnt lgkmcnt(0)
    s_mov_b32 s89, 0
    s_nop 0
F_A_L:
    v_min3_u32 v236, v236, v237, v238
    v_min_u32 v236, v236, v239
    v_cmp_gt_u32 vcc, 1, v236
    s_nop 3
    s_cbranch_vccz F_A_D
    s_add_u32 s89, s89, 1
    s_cmp_ge_u32 s89, 320000
    s_cbranch_scc1 F_A_D
    ds_read_b128 v[236:239], v11 offset:16
    s_waitcnt lgkmcnt(0)
    s_branch F_A_L
    s_nop 0
F_A_D:
    ds_read_b64_tr_b16 v[80:81], v212 offset:0
    ds_read_b64_tr_b16 v[82:83], v212 offset:512
    ds_read_b64_tr_b16 v[84:85], v212 offset:1024
    ds_read_b64_tr_b16 v[86:87], v212 offset:1536
    ds_read_b64_tr_b16 v[88:89], v212 offset:2048
    ds_read_b64_tr_b16 v[90:91], v212 offset:2560
    ds_read_b64_tr_b16 v[92:93], v212 offset:3072
    ds_read_b64_tr_b16 v[94:95], v212 offset:3584
    ds_read_b64_tr_b16 v[96:97], v212 offset:4096
    ds_read_b64_tr_b16 v[98:99], v212 offset:4608
    ds_read_b64_tr_b16 v[100:101], v212 offset:5120
    ds_read_b64_tr_b16 v[102:103], v212 offset:5632
    s_waitcnt lgkmcnt(4)
    ds_read_b64_tr_b16 v[104:105], v212 offset:6144
    ds_read_b64_tr_b16 v[106:107], v212 offset:6656
    ds_read_b64_tr_b16 v[108:109], v212 offset:7168
    ds_read_b64_tr_b16 v[110:111], v212 offset:7680
    ds_read_b64_tr_b16 v[112:113], v212 offset:8192
    ds_read_b64_tr_b16 v[114:115], v212 offset:8704
    ds_read_b64_tr_b16 v[116:117], v212 offset:9216
    ds_read_b64_tr_b16 v[118:119], v212 offset:9728
    s_lshl_b32 s33, s24, 9
    s_add_u32 s33, s33, 151552
    v_lshlrev_b32 v4, 5, v3
    v_lshl_add_u32 v4, v2, 3, v4
    v_add_u32 v4, s33, v4
    ds_read_b64 v[240:241], v4 offset:6144
    ds_read_b64 v[242:243], v4 offset:8192
    s_waitcnt lgkmcnt(2)
    v_mfma_f32_16x16x32_bf16 v[120:123], v[180:183], v[80:83], 0
    v_mfma_f32_16x16x32_bf16 v[124:127], v[180:183], v[88:91], 0
    v_mfma_f32_16x16x32_bf16 v[128:131], v[180:183], v[96:99], 0
    v_mfma_f32_16x16x32_bf16 v[132:135], v[180:183], v[104:107], 0
    v_mfma_f32_16x16x32_bf16 v[136:139], v[180:183], v[112:115], 0
    v_mfma_f32_16x16x32_bf16 v[120:123], v[184:187], v[84:87], v[120:123]
    v_mfma_f32_16x16x32_bf16 v[124:127], v[184:187], v[92:95], v[124:127]
    v_mfma_f32_16x16x32_bf16 v[128:131], v[184:187], v[100:103], v[128:131]
    v_mfma_f32_16x16x32_bf16 v[132:135], v[184:187], v[108:111], v[132:135]
    v_mfma_f32_16x16x32_bf16 v[136:139], v[184:187], v[116:119], v[136:139]
    s_cmp_eq_u32 s24, 0
    s_cselect_b32 s86, 0xffff, 0
    s_mov_b32 s87, 0
    s_nop 4
    v_pk_add_f32 v[80:81], v[124:125], v[136:137]
    v_pk_add_f32 v[82:83], v[124:125], v[136:137] neg_lo:[0,1] neg_hi:[0,1]
    v_pk_add_f32 v[84:85], v[128:129], v[132:133]
    v_pk_add_f32 v[86:87], v[128:129], v[132:133] neg_lo:[0,1] neg_hi:[0,1]
    v_pk_add_f32 v[96:97], v[120:121], v[80:81]
    v_pk_fma_f32 v[88:89], v[80:81], s[78:79], v[120:121]
    v_pk_fma_f32 v[90:91], v[80:81], s[80:81], v[120:121]
    v_pk_mul_f32 v[92:93], v[82:83], s[82:83]
    v_pk_mul_f32 v[94:95], v[82:83], s[84:85]
    v_pk_add_f32 v[96:97], v[96:97], v[84:85]
    v_pk_fma_f32 v[88:89], v[84:85], s[80:81], v[88:89]
    v_pk_fma_f32 v[90:91], v[84:85], s[78:79], v[90:91]
    v_pk_fma_f32 v[92:93], v[86:87], s[84:85], v[92:93]
    v_pk_fma_f32 v[94:95], v[86:87], s[82:83], v[94:95] neg_lo:[1,0,0] neg_hi:[1,0,0]
    v_add_f32 v80, v88, v93
    v_sub_f32 v81, v89, v92
    v_sub_f32 v82, v88, v93
    v_add_f32 v83, v89, v92
    v_add_f32 v84, v90, v95
    v_sub_f32 v85, v91, v94
    v_sub_f32 v86, v90, v95
    v_add_f32 v87, v91, v94
    v_cndmask_b32 v80, v80, v88, s[86:87]
    v_cndmask_b32 v81, v81, -v92, s[86:87]
    v_cndmask_b32 v82, v82, v89, s[86:87]
    v_cndmask_b32 v83, v83, v93, s[86:87]
    v_cndmask_b32 v84, v84, v91, s[86:87]
    v_cndmask_b32 v85, v85, -v95, s[86:87]
    v_cndmask_b32 v86, v86, v90, s[86:87]
    v_cndmask_b32 v87, v87, v94, s[86:87]
    v_cvt_pk_bf16_f32 v140, v96, v97
    v_pk_mul_f32 v[88:89], v[86:87], v[204:205] op_sel:[0,0] op_sel_hi:[1,0]
    v_pk_fma_f32 v[88:89], v[86:87], v[204:205], v[88:89] op_sel:[1,1,0] op_sel_hi:[0,1,1] neg_hi:[0,1,0]
    v_pk_mul_f32 v[90:91], v[80:81], v[206:207] op_sel:[0,0] op_sel_hi:[1,0]
    v_pk_fma_f32 v[90:91], v[80:81], v[206:207], v[90:91] op_sel:[1,1,0] op_sel_hi:[0,1,1] neg_hi:[0,1,0]
    v_pk_mul_f32 v[92:93], v[82:83], v[206:207] op_sel:[0,0] op_sel_hi:[1,0]
    v_pk_fma_f32 v[92:93], v[82:83], v[206:207], v[92:93] op_sel:[1,1,0] op_sel_hi:[0,1,1] neg_lo:[0,1,0]
    v_pk_mul_f32 v[94:95], v[84:85], v[204:205] op_sel:[0,0] op_sel_hi:[1,0]
    v_pk_fma_f32 v[94:95], v[84:85], v[204:205], v[94:95] op_sel:[1,1,0] op_sel_hi:[0,1,1] neg_lo:[0,1,0]
    v_cvt_pk_bf16_f32 v141, v88, v89
    v_cvt_pk_bf16_f32 v142, v90, v91
    v_cvt_pk_bf16_f32 v143, v92, v93
    v_cvt_pk_bf16_f32 v144, v94, v95
    v_pk_add_f32 v[100:101], v[126:127], v[138:139]
    v_pk_add_f32 v[102:103], v[126:127], v[138:139] neg_lo:[0,1] neg_hi:[0,1]
    v_pk_add_f32 v[104:105], v[130:131], v[134:135]
    v_pk_add_f32 v[106:107], v[130:131], v[134:135] neg_lo:[0,1] neg_hi:[0,1]
    v_pk_add_f32 v[116:117], v[122:123], v[100:101]
    v_pk_fma_f32 v[108:109], v[100:101], s[78:79], v[122:123]
    v_pk_fma_f32 v[110:111], v[100:101], s[80:81], v[122:123]
    v_pk_mul_f32 v[112:113], v[102:103], s[82:83]
    v_pk_mul_f32 v[114:115], v[102:103], s[84:85]
    v_pk_add_f32 v[116:117], v[116:117], v[104:105]
    v_pk_fma_f32 v[108:109], v[104:105], s[80:81], v[108:109]
    v_pk_fma_f32 v[110:111], v[104:105], s[78:79], v[110:111]
    v_pk_fma_f32 v[112:113], v[106:107], s[84:85], v[112:113]
    v_pk_fma_f32 v[114:115], v[106:107], s[82:83], v[114:115] neg_lo:[1,0,0] neg_hi:[1,0,0]
    v_add_f32 v100, v108, v113
    v_sub_f32 v101, v109, v112
    v_sub_f32 v102, v108, v113
    v_add_f32 v103, v109, v112
    v_add_f32 v104, v110, v115
    v_sub_f32 v105, v111, v114
    v_sub_f32 v106, v110, v115
    v_add_f32 v107, v111, v114
    v_cvt_pk_bf16_f32 v145, v116, v117
    v_pk_mul_f32 v[108:109], v[106:107], v[204:205] op_sel:[0,0] op_sel_hi:[1,0]
    v_pk_fma_f32 v[108:109], v[106:107], v[204:205], v[108:109] op_sel:[1,1,0] op_sel_hi:[0,1,1] neg_hi:[0,1,0]
    v_pk_mul_f32 v[110:111], v[100:101], v[206:207] op_sel:[0,0] op_sel_hi:[1,0]
    v_pk_fma_f32 v[110:111], v[100:101], v[206:207], v[110:111] op_sel:[1,1,0] op_sel_hi:[0,1,1] neg_hi:[0,1,0]
    v_pk_mul_f32 v[112:113], v[102:103], v[206:207] op_sel:[0,0] op_sel_hi:[1,0]
    v_pk_fma_f32 v[112:113], v[102:103], v[206:207], v[112:113] op_sel:[1,1,0] op_sel_hi:[0,1,1] neg_lo:[0,1,0]
    v_pk_mul_f32 v[114:115], v[104:105], v[204:205] op_sel:[0,0] op_sel_hi:[1,0]
    v_pk_fma_f32 v[114:115], v[104:105], v[204:205], v[114:115] op_sel:[1,1,0] op_sel_hi:[0,1,1] neg_lo:[0,1,0]
    v_cvt_pk_bf16_f32 v146, v108, v109
    v_cvt_pk_bf16_f32 v147, v110, v111
    v_cvt_pk_bf16_f32 v148, v112, v113
    v_cvt_pk_bf16_f32 v149, v114, v115
    v_mov_b32_dpp v80, v140 quad_perm:[1,0,3,2] row_mask:0xf bank_mask:0xf
    v_mov_b32_dpp v81, v141 quad_perm:[1,0,3,2] row_mask:0xf bank_mask:0xf
    v_mov_b32_dpp v82, v142 quad_perm:[1,0,3,2] row_mask:0xf bank_mask:0xf
    v_mov_b32_dpp v83, v143 quad_perm:[1,0,3,2] row_mask:0xf bank_mask:0xf
    v_mov_b32_dpp v84, v144 quad_perm:[1,0,3,2] row_mask:0xf bank_mask:0xf
    v_mov_b32_dpp v85, v145 quad_perm:[1,0,3,2] row_mask:0xf bank_mask:0xf
    v_mov_b32_dpp v86, v146 quad_perm:[1,0,3,2] row_mask:0xf bank_mask:0xf
    v_mov_b32_dpp v87, v147 quad_perm:[1,0,3,2] row_mask:0xf bank_mask:0xf
    v_mov_b32_dpp v88, v148 quad_perm:[1,0,3,2] row_mask:0xf bank_mask:0xf
    v_mov_b32_dpp v89, v149 quad_perm:[1,0,3,2] row_mask:0xf bank_mask:0xf
    v_perm_b32 v140, v80, v140, v210
    v_perm_b32 v141, v81, v141, v210
    v_perm_b32 v142, v82, v142, v210
    v_perm_b32 v143, v83, v143, v210
    v_perm_b32 v144, v84, v144, v210
    v_perm_b32 v145, v85, v145, v210
    v_perm_b32 v146, v86, v146, v210
    v_perm_b32 v147, v87, v147, v210
    v_perm_b32 v148, v88, v148, v210
    v_perm_b32 v149, v89, v149, v210
    v_mov_b32 v139, v211
    s_waitcnt vmcnt(2)
    v_lshlrev_b32 v164, 16, v164
    v_lshlrev_b32 v165, 16, v165
    v_lshlrev_b32 v166, 16, v166
    v_mul_f32 v82, 0x3fb8aa3b, v166
    v_exp_f32 v82, v82
    s_nop 0
    v_cvt_pk_bf16_f32 v82, v82, v82
    v_and_b32 v82, 0xffff0000, v82
    v_mul_f32 v80, v82, v164
    v_mul_f32 v81, v82, v165
    v_mul_f32 v80, 0x3fb8aa3b, v80
    v_mul_f32 v81, 0x3e22f983, v81
    v_fract_f32 v82, v81
    v_exp_f32 v83, v80
    v_cos_f32 v84, v82
    v_sin_f32 v85, v82
    v_mul_f32 v84, v84, v83
    v_mul_f32 v85, v85, v83
    v_add_f32 v84, -1.0, v84
    v_mul_f32 v80, v164, v164
    v_fmac_f32 v80, v165, v165
    v_rcp_f32 v80, v80
    v_mul_f32 v86, v84, v164
    v_fmac_f32 v86, v85, v165
    v_mul_f32 v87, v85, v164
    v_fma_f32 v87, -v84, v165, v87
    v_add_f32 v80, v80, v80
    v_mul_f32 v86, v86, v80
    v_mul_f32 v87, v87, v80
    s_nop 0
    v_mov_b32_dpp v88, v86 row_newbcast:0 row_mask:0xf bank_mask:0xf
    v_mov_b32_dpp v89, v87 row_newbcast:0 row_mask:0xf bank_mask:0xf
    v_mov_b32_dpp v90, v86 row_newbcast:1 row_mask:0xf bank_mask:0xf
    v_mov_b32_dpp v91, v87 row_newbcast:1 row_mask:0xf bank_mask:0xf
    v_mov_b32_dpp v92, v86 row_newbcast:2 row_mask:0xf bank_mask:0xf
    v_mov_b32_dpp v93, v87 row_newbcast:2 row_mask:0xf bank_mask:0xf
    v_mov_b32_dpp v94, v86 row_newbcast:3 row_mask:0xf bank_mask:0xf
    v_mov_b32_dpp v95, v87 row_newbcast:3 row_mask:0xf bank_mask:0xf
    v_mov_b32_dpp v96, v86 row_newbcast:4 row_mask:0xf bank_mask:0xf
    v_mov_b32_dpp v97, v87 row_newbcast:4 row_mask:0xf bank_mask:0xf
    v_mov_b32_dpp v98, v86 row_newbcast:5 row_mask:0xf bank_mask:0xf
    v_mov_b32_dpp v99, v87 row_newbcast:5 row_mask:0xf bank_mask:0xf
    v_mov_b32_dpp v100, v86 row_newbcast:6 row_mask:0xf bank_mask:0xf
    v_mov_b32_dpp v101, v87 row_newbcast:6 row_mask:0xf bank_mask:0xf
    v_mov_b32_dpp v102, v86 row_newbcast:7 row_mask:0xf bank_mask:0xf
    v_mov_b32_dpp v103, v87 row_newbcast:7 row_mask:0xf bank_mask:0xf
    v_lshlrev_b32 v112, 16, v168
    v_lshlrev_b32 v113, 16, v172
    v_pk_mul_f32 v[114:115], v[112:113], v[88:89] op_sel:[0,0] op_sel_hi:[1,0] neg_hi:[1,0]
    v_pk_fma_f32 v[114:115], v[112:113], v[88:89], v[114:115] op_sel:[1,1,0] op_sel_hi:[0,1,1] neg_lo:[1,0,0] neg_hi:[1,0,0]
    v_cvt_pk_bf16_f32 v104, v114, v115
    v_and_b32 v116, 0xffff0000, v168
    v_and_b32 v117, 0xffff0000, v172
    v_pk_mul_f32 v[118:119], v[116:117], v[90:91] op_sel:[0,0] op_sel_hi:[1,0] neg_hi:[1,0]
    v_pk_fma_f32 v[118:119], v[116:117], v[90:91], v[118:119] op_sel:[1,1,0] op_sel_hi:[0,1,1] neg_lo:[1,0,0] neg_hi:[1,0,0]
    v_cvt_pk_bf16_f32 v105, v118, v119
    v_lshlrev_b32 v120, 16, v169
    v_lshlrev_b32 v121, 16, v173
    v_pk_mul_f32 v[122:123], v[120:121], v[92:93] op_sel:[0,0] op_sel_hi:[1,0] neg_hi:[1,0]
    v_pk_fma_f32 v[122:123], v[120:121], v[92:93], v[122:123] op_sel:[1,1,0] op_sel_hi:[0,1,1] neg_lo:[1,0,0] neg_hi:[1,0,0]
    v_cvt_pk_bf16_f32 v106, v122, v123
    v_and_b32 v124, 0xffff0000, v169
    v_and_b32 v125, 0xffff0000, v173
    v_pk_mul_f32 v[126:127], v[124:125], v[94:95] op_sel:[0,0] op_sel_hi:[1,0] neg_hi:[1,0]
    v_pk_fma_f32 v[126:127], v[124:125], v[94:95], v[126:127] op_sel:[1,1,0] op_sel_hi:[0,1,1] neg_lo:[1,0,0] neg_hi:[1,0,0]
    v_cvt_pk_bf16_f32 v107, v126, v127
    v_lshlrev_b32 v112, 16, v170
    v_lshlrev_b32 v113, 16, v174
    v_pk_mul_f32 v[114:115], v[112:113], v[96:97] op_sel:[0,0] op_sel_hi:[1,0] neg_hi:[1,0]
    v_pk_fma_f32 v[114:115], v[112:113], v[96:97], v[114:115] op_sel:[1,1,0] op_sel_hi:[0,1,1] neg_lo:[1,0,0] neg_hi:[1,0,0]
    v_cvt_pk_bf16_f32 v108, v114, v115
    v_and_b32 v116, 0xffff0000, v170
    v_and_b32 v117, 0xffff0000, v174
    v_pk_mul_f32 v[118:119], v[116:117], v[98:99] op_sel:[0,0] op_sel_hi:[1,0] neg_hi:[1,0]
    v_pk_fma_f32 v[118:119], v[116:117], v[98:99], v[118:119] op_sel:[1,1,0] op_sel_hi:[0,1,1] neg_lo:[1,0,0] neg_hi:[1,0,0]
    v_cvt_pk_bf16_f32 v109, v118, v119
    v_lshlrev_b32 v120, 16, v171
    v_lshlrev_b32 v121, 16, v175
    v_pk_mul_f32 v[122:123], v[120:121], v[100:101] op_sel:[0,0] op_sel_hi:[1,0] neg_hi:[1,0]
    v_pk_fma_f32 v[122:123], v[120:121], v[100:101], v[122:123] op_sel:[1,1,0] op_sel_hi:[0,1,1] neg_lo:[1,0,0] neg_hi:[1,0,0]
    v_cvt_pk_bf16_f32 v110, v122, v123
    v_and_b32 v124, 0xffff0000, v171
    v_and_b32 v125, 0xffff0000, v175
    v_pk_mul_f32 v[126:127], v[124:125], v[102:103] op_sel:[0,0] op_sel_hi:[1,0] neg_hi:[1,0]
    v_pk_fma_f32 v[126:127], v[124:125], v[102:103], v[126:127] op_sel:[1,1,0] op_sel_hi:[0,1,1] neg_lo:[1,0,0] neg_hi:[1,0,0]
    v_cvt_pk_bf16_f32 v111, v126, v127
    v_lshlrev_b32 v138, 9, v2
    v_lshl_add_u32 v138, v3, 4, v138
    s_and_b32 s75, s95, 7
    s_mul_i32 s75, s75, 5
    s_lshr_b32 s33, s95, 3
    s_add_u32 s75, s75, s33
    s_mul_i32 s75, s75, 40960
    s_lshl_b32 s33, s96, 11
    s_add_u32 s75, s75, s33
    s_add_u32 s75, s75, 10510336
    s_and_b32 s92, s95, 7
    s_mul_i32 s92, s92, 5
    s_lshr_b32 s33, s96, 2
    s_add_u32 s92, s92, s33
    s_add_u32 s92, s92, 80
    s_lshl_b32 s92, s92, 2
    s_lshl_b32 s92, s92, 7
    s_add_u32 s92, s92, 12337152
    s_cmp_lt_u32 s2, 200
    s_cselect_b32 s75, s75, 1073741824
    s_cselect_b32 s92, s92, 1073741824
    s_mov_b32 s48, s75
    ds_read_b128 v[132:135], v11 offset:0
    s_waitcnt lgkmcnt(0)
    s_mov_b32 s89, 0
    s_nop 0
F_GM_L:
    v_min3_u32 v132, v132, v133, v134
    v_min_u32 v132, v132, v135
    v_cmp_gt_u32 vcc, 2, v132
    s_nop 3
    s_cbranch_vccz F_GM_D
    s_add_u32 s89, s89, 1
    s_cmp_ge_u32 s89, 320000
    s_cbranch_scc1 F_GM_D
    s_sleep 2
    ds_read_b128 v[132:135], v11 offset:0
    s_waitcnt lgkmcnt(0)
    s_branch F_GM_L
    s_nop 0
F_GM_D:
    s_mov_b32 s16, s38
    s_mov_b32 s17, s39
    s_mov_b32 s18, 1314816
    s_mov_b32 s19, 0x20000
    s_mov_b32 s20, s40
    s_mov_b32 s21, s41
    s_mov_b32 s22, 1314816
    s_mov_b32 s23, 0x20000
    v_cmp_gt_u32 vcc, 42, v1
    v_mov_b32 v137, 1073741824
    s_nop 0
    v_cndmask_b32 v137, v137, v6, vcc
    s_lshl_b32 s68, s24, 3
    s_and_b32 s33, s2, 7
    s_add_u32 s68, s68, s33
    s_mul_i32 s76, s68, 81920
    s_lshl_b32 s33, s35, 9
    s_add_u32 s76, s76, s33
    s_add_u32 s76, s76, 12791808
    s_mov_b32 s72, s68
    s_lshl_b32 s33, s35, 6
    s_add_u32 s68, s68, s33
    s_lshl_b32 s71, s24, 12
    s_add_u32 s71, s71, 131072
    s_setprio 3
    s_cmp_lg_u32 s72, 0
    s_cbranch_scc1 F_WB0
    s_mov_b32 s73, 147456
    s_add_u32 s33, s68, 32
    s_sub_u32 s34, 2048, s33
    s_and_b32 s34, s34, 2047
    s_mul_i32 s33, s33, 642
    s_and_b32 s74, s33, 15
    s_sub_u32 s33, s33, s74
    s_add_u32 m0, s73, 0
    s_nop 0
    buffer_load_dwordx4 v137, s[16:19], s33 offen lds
    s_add_u32 m0, s73, 2048
    s_nop 0
    buffer_load_dwordx4 v137, s[20:23], s33 offen lds
    s_mul_i32 s34, s34, 642
    s_and_b32 s75, s34, 15
    s_sub_u32 s34, s34, s75
    s_add_u32 m0, s73, 1024
    s_nop 0
    buffer_load_dwordx4 v137, s[16:19], s34 offen lds
    s_add_u32 m0, s73, 3072
    s_nop 0
    buffer_load_dwordx4 v137, s[20:23], s34 offen lds
    s_nop 1
F_WB0:
    s_add_u32 s33, s68, 0
    s_sub_u32 s34, 2048, s33
    s_and_b32 s34, s34, 2047
    s_mul_i32 s33, s33, 642
    s_and_b32 s69, s33, 15
    s_sub_u32 s33, s33, s69
    s_add_u32 m0, s71, 0
    s_nop 0
    buffer_load_dwordx4 v137, s[16:19], s33 offen lds
    s_add_u32 m0, s71, 2048
    s_nop 0
    buffer_load_dwordx4 v137, s[20:23], s33 offen lds
    s_mul_i32 s34, s34, 642
    s_and_b32 s70, s34, 15
    s_sub_u32 s34, s34, s70
    s_add_u32 m0, s71, 1024
    s_nop 0
    buffer_load_dwordx4 v137, s[16:19], s34 offen lds
    s_add_u32 m0, s71, 3072
    s_nop 0
    buffer_load_dwordx4 v137, s[20:23], s34 offen lds
    s_setprio 0
    s_setprio 3
    global_load_dwordx2 v[134:135], v10, s[64:65] sc1
    s_add_u32 s32, s93, 5251072
    buffer_store_dword v140, v139, s[4:7], s32 offen sc0 sc1
    s_add_u32 s32, s93, 5267456
    buffer_store_dword v141, v139, s[4:7], s32 offen sc0 sc1
    s_add_u32 s32, s93, 5283840
    buffer_store_dword v142, v139, s[4:7], s32 offen sc0 sc1
    s_add_u32 s32, s93, 5300224
    buffer_store_dword v143, v139, s[4:7], s32 offen sc0 sc1
    s_add_u32 s32, s93, 5316608
    buffer_store_dword v144, v139, s[4:7], s32 offen sc0 sc1
    s_add_u32 s32, s93, 5332992
    buffer_store_dword v145, v139, s[4:7], s32 offen sc0 sc1
    s_add_u32 s32, s93, 5349376
    buffer_store_dword v146, v139, s[4:7], s32 offen sc0 sc1
    s_add_u32 s32, s93, 5365760
    buffer_store_dword v147, v139, s[4:7], s32 offen sc0 sc1
    s_add_u32 s32, s93, 5382144
    buffer_store_dword v148, v139, s[4:7], s32 offen sc0 sc1
    s_add_u32 s32, s93, 5398528
    buffer_store_dword v149, v139, s[4:7], s32 offen sc0 sc1
    buffer_store_dwordx4 v[104:107], v138, s[4:7], s48 offen offset:0 sc0 sc1
    buffer_store_dwordx4 v[108:111], v138, s[4:7], s48 offen offset:256 sc0 sc1
    s_setprio 0
    v_cvt_f32_u32 v251, v7
    v_mul_f32 v251, 0x3d000000, v251
    v_cvt_f32_u32 v4, s29
    v_fmamk_f32 v4, v4, 0x3c800000, v245
    v_mul_f32 v255, v251, v4
    v_fmamk_f32 v216, v251, 0x00000000, v255
    v_fmamk_f32 v217, v251, 0x3f800000, v255
    v_fmamk_f32 v218, v251, 0x40000000, v255
    v_fmamk_f32 v219, v251, 0x40400000, v255
    v_fmamk_f32 v220, v251, 0x41000000, v255
    v_fmamk_f32 v221, v251, 0x41100000, v255
    v_fmamk_f32 v222, v251, 0x41200000, v255
    v_fmamk_f32 v223, v251, 0x41300000, v255
    v_cos_f32 v224, v216
    v_cos_f32 v225, v217
    v_cos_f32 v226, v218
    v_cos_f32 v227, v219
    v_cos_f32 v228, v220
    v_cos_f32 v229, v221
    v_cos_f32 v230, v222
    v_cos_f32 v231, v223
    v_sin_f32 v216, v216
    v_sin_f32 v217, v217
    v_sin_f32 v218, v218
    v_sin_f32 v219, v219
    v_sin_f32 v220, v220
    v_sin_f32 v221, v221
    v_sin_f32 v222, v222
    v_sin_f32 v223, v223
    v_cvt_pk_bf16_f32 v184, v224, v225
    v_cvt_pk_bf16_f32 v185, v226, v227
    v_cvt_pk_bf16_f32 v186, v228, v229
    v_cvt_pk_bf16_f32 v187, v230, v231
    v_cvt_pk_bf16_f32 v192, v216, v217
    v_cvt_pk_bf16_f32 v193, v218, v219
    v_cvt_pk_bf16_f32 v194, v220, v221
    v_cvt_pk_bf16_f32 v195, v222, v223
    v_cvt_pk_bf16_f32 v200, -v216, -v217
    v_cvt_pk_bf16_f32 v201, -v218, -v219
    v_cvt_pk_bf16_f32 v202, -v220, -v221
    v_cvt_pk_bf16_f32 v203, -v222, -v223
    v_fmamk_f32 v216, v251, 0x41800000, v255
    v_fmamk_f32 v217, v251, 0x41880000, v255
    v_fmamk_f32 v218, v251, 0x41900000, v255
    v_fmamk_f32 v219, v251, 0x41980000, v255
    v_fmamk_f32 v220, v251, 0x41c00000, v255
    v_fmamk_f32 v221, v251, 0x41c80000, v255
    v_fmamk_f32 v222, v251, 0x41d00000, v255
    v_fmamk_f32 v223, v251, 0x41d80000, v255
    v_cos_f32 v224, v216
    v_cos_f32 v225, v217
    v_cos_f32 v226, v218
    v_cos_f32 v227, v219
    v_cos_f32 v228, v220
    v_cos_f32 v229, v221
    v_cos_f32 v230, v222
    v_cos_f32 v231, v223
    v_sin_f32 v216, v216
    v_sin_f32 v217, v217
    v_sin_f32 v218, v218
    v_sin_f32 v219, v219
    v_sin_f32 v220, v220
    v_sin_f32 v221, v221
    v_sin_f32 v222, v222
    v_sin_f32 v223, v223
    v_cvt_pk_bf16_f32 v188, v224, v225
    v_cvt_pk_bf16_f32 v189, v226, v227
    v_cvt_pk_bf16_f32 v190, v228, v229
    v_cvt_pk_bf16_f32 v191, v230, v231
    v_cvt_pk_bf16_f32 v196, v216, v217
    v_cvt_pk_bf16_f32 v197, v218, v219
    v_cvt_pk_bf16_f32 v198, v220, v221
    v_cvt_pk_bf16_f32 v199, v222, v223
    v_cvt_pk_bf16_f32 v204, -v216, -v217
    v_cvt_pk_bf16_f32 v205, -v218, -v219
    v_cvt_pk_bf16_f32 v206, -v220, -v221
    v_cvt_pk_bf16_f32 v207, -v222, -v223
    v_lshlrev_b32 v5, 6, v7
    v_add_u32 v5, s29, v5
    v_cvt_f32_u32 v251, v5
    v_mul_f32 v251, 0x3a000000, v251
    v_mul_f32 v255, v251, v245
    v_fmamk_f32 v220, v251, 0x00000000, v255
    v_fmamk_f32 v221, v251, 0x3f800000, v255
    v_fmamk_f32 v222, v251, 0x40000000, v255
    v_fmamk_f32 v223, v251, 0x40400000, v255
    v_fmamk_f32 v224, v251, 0x41000000, v255
    v_fmamk_f32 v225, v251, 0x41100000, v255
    v_fmamk_f32 v226, v251, 0x41200000, v255
    v_fmamk_f32 v227, v251, 0x41300000, v255
    v_cos_f32 v228, v220
    v_cos_f32 v229, v221
    v_cos_f32 v230, v222
    v_cos_f32 v231, v223
    v_cos_f32 v232, v224
    v_cos_f32 v233, v225
    v_cos_f32 v234, v226
    v_cos_f32 v235, v227
    v_sin_f32 v220, v220
    v_sin_f32 v221, v221
    v_sin_f32 v222, v222
    v_sin_f32 v223, v223
    v_sin_f32 v224, v224
    v_sin_f32 v225, v225
    v_sin_f32 v226, v226
    v_sin_f32 v227, v227
    v_cvt_pk_bf16_f32 v160, v228, v229
    v_cvt_pk_bf16_f32 v161, v230, v231
    v_cvt_pk_bf16_f32 v162, v232, v233
    v_cvt_pk_bf16_f32 v163, v234, v235
    v_cvt_pk_bf16_f32 v168, v220, v221
    v_cvt_pk_bf16_f32 v169, v222, v223
    v_cvt_pk_bf16_f32 v170, v224, v225
    v_cvt_pk_bf16_f32 v171, v226, v227
    v_cvt_pk_bf16_f32 v176, -v220, -v221
    v_cvt_pk_bf16_f32 v177, -v222, -v223
    v_cvt_pk_bf16_f32 v178, -v224, -v225
    v_cvt_pk_bf16_f32 v179, -v226, -v227
    v_fmamk_f32 v220, v251, 0x41800000, v255
    v_fmamk_f32 v221, v251, 0x41880000, v255
    v_fmamk_f32 v222, v251, 0x41900000, v255
    v_fmamk_f32 v223, v251, 0x41980000, v255
    v_fmamk_f32 v224, v251, 0x41c00000, v255
    v_fmamk_f32 v225, v251, 0x41c80000, v255
    v_fmamk_f32 v226, v251, 0x41d00000, v255
    v_fmamk_f32 v227, v251, 0x41d80000, v255
    v_cos_f32 v228, v220
    v_cos_f32 v229, v221
    v_cos_f32 v230, v222
    v_cos_f32 v231, v223
    v_cos_f32 v232, v224
    v_cos_f32 v233, v225
    v_cos_f32 v234, v226
    v_cos_f32 v235, v227
    v_sin_f32 v220, v220
    v_sin_f32 v221, v221
    v_sin_f32 v222, v222
    v_sin_f32 v223, v223
    v_sin_f32 v224, v224
    v_sin_f32 v225, v225
    v_sin_f32 v226, v226
    v_sin_f32 v227, v227
    v_cvt_pk_bf16_f32 v164, v228, v229
    v_cvt_pk_bf16_f32 v165, v230, v231
    v_cvt_pk_bf16_f32 v166, v232, v233
    v_cvt_pk_bf16_f32 v167, v234, v235
    v_cvt_pk_bf16_f32 v172, v220, v221
    v_cvt_pk_bf16_f32 v173, v222, v223
    v_cvt_pk_bf16_f32 v174, v224, v225
    v_cvt_pk_bf16_f32 v175, v226, v227
    v_cvt_pk_bf16_f32 v180, -v220, -v221
    v_cvt_pk_bf16_f32 v181, -v222, -v223
    v_cvt_pk_bf16_f32 v182, -v224, -v225
    v_cvt_pk_bf16_f32 v183, -v226, -v227
    s_and_b32 s94, s2, 7
    s_lshl_b32 s94, s94, 3
    s_add_u32 s94, s94, s35
    s_sub_u32 s94, s94, 24
    s_lshl_b32 s94, s94, 2
    s_add_u32 s94, s94, s24
    s_lshl_b32 s94, s94, 3
    s_lshl_b32 s90, s24, 12
    s_lshl_b32 s91, s24, 2
    s_lshr_b32 s33, s28, 1
    s_add_u32 s91, s91, s33
    s_add_u32 s91, s91, 32
    s_lshl_b32 s91, s91, 2
    s_lshl_b32 s91, s91, 7
    s_add_u32 s91, s91, 12337152
    v_bfe_u32 v154, v1, 1, 1
    v_lshlrev_b32 v153, 10, v154
    v_and_b32 v5, 1, v1
    v_lshl_add_u32 v153, v5, 9, v153
    v_lshrrev_b32 v5, 2, v1
    v_lshl_add_u32 v153, v5, 4, v153
    v_add_u32 v153, s90, v153
    s_mul_i32 s40, s31, 205
    s_lshr_b32 s40, s40, 13
    s_and_b32 s40, s40, 3
    s_lshl_b32 s40, s40, 2
    s_add_u32 s40, s40, s24
    s_add_u32 s40, s40, 32
    s_and_b32 s33, s31, 3
    s_lshl_b32 s40, s40, 2
    s_add_u32 s40, s40, s33
    s_lshl_b32 s40, s40, 7
    s_add_u32 s40, s40, 12337152
    s_waitcnt vmcnt(0)
    v_cmp_eq_u32 vcc, 0, v134
    v_cmp_ne_u32 s[86:87], 8, v135
    s_nop 0
    s_or_b64 vcc, vcc, s[86:87]
    s_mov_b32 s89, 0
    s_nop 1
F_NON_L:
    s_cbranch_vccz F_NON_D
    s_add_u32 s89, s89, 1
    s_cmp_ge_u32 s89, 40000
    s_cbranch_scc1 F_NON_D
    s_sleep 8
    global_load_dwordx2 v[134:135], v10, s[64:65] sc1
    s_waitcnt vmcnt(0)
    v_cmp_eq_u32 vcc, 0, v134
    v_cmp_ne_u32 s[86:87], 8, v135
    s_nop 0
    s_or_b64 vcc, vcc, s[86:87]
    s_nop 1
    s_branch F_NON_L
    s_nop 0
F_NON_D:
    v_readfirstlane_b32 s43, v134
    s_setprio 3
    v_mov_b32 v156, 1
    v_lshlrev_b32 v157, 7, v1
    s_mov_b64 exec, 15
    buffer_atomic_add v156, v157, s[4:7], s91 offen sc1
    s_mov_b64 exec, -1
    v_mov_b32 v158, 1
    v_lshlrev_b32 v159, 7, v1
    s_mov_b64 exec, 15
    buffer_atomic_add v158, v159, s[4:7], s92 offen sc1
    s_mov_b64 exec, -1
    s_setprio 0
    s_add_u32 s33, s69, s71
    s_add_u32 s34, s70, s71
    s_add_u32 s34, s34, 2304
    v_mov_b32 v100, s34
    v_mul_u32_u24 v101, 20, v1
    v_bfrev_b32 v103, 1
    v_add_u32 v4, 0, v101
    v_subrev_u32 v5, 1280, v4
    v_min_u32 v4, v4, v5
    v_cmp_lt_u32 vcc, 640, v4
    v_sub_u32 v5, v100, v4
    v_add_u32 v102, s33, v4
    v_cndmask_b32 v80, v102, v5, vcc
    v_cndmask_b32 v90, 0, v103, vcc
    v_add_u32 v104, v100, v4
    ds_read_u16 v112, v80
    ds_read_u16 v122, v80 offset:2048
    v_add_u32 v4, 10, v101
    v_subrev_u32 v5, 1280, v4
    v_min_u32 v4, v4, v5
    v_cmp_lt_u32 vcc, 640, v4
    v_sub_u32 v5, v100, v4
    v_add_u32 v102, s33, v4
    v_cndmask_b32 v81, v102, v5, vcc
    v_cndmask_b32 v91, 0, v103, vcc
    ds_read_u16 v113, v81
    ds_read_u16 v123, v81 offset:2048
    v_add_u32 v4, 256, v101
    v_subrev_u32 v5, 1280, v4
    v_min_u32 v4, v4, v5
    v_cmp_lt_u32 vcc, 640, v4
    v_sub_u32 v5, v100, v4
    v_add_u32 v102, s33, v4
    v_cndmask_b32 v82, v102, v5, vcc
    v_cndmask_b32 v92, 0, v103, vcc
    ds_read_u16 v114, v82
    ds_read_u16 v124, v82 offset:2048
    v_add_u32 v4, 266, v101
    v_subrev_u32 v5, 1280, v4
    v_min_u32 v4, v4, v5
    v_cmp_lt_u32 vcc, 640, v4
    v_sub_u32 v5, v100, v4
    v_add_u32 v102, s33, v4
    v_cndmask_b32 v83, v102, v5, vcc
    v_cndmask_b32 v93, 0, v103, vcc
    ds_read_u16 v115, v83
    ds_read_u16 v125, v83 offset:2048
    v_add_u32 v4, 512, v101
    v_subrev_u32 v5, 1280, v4
    v_min_u32 v4, v4, v5
    v_cmp_lt_u32 vcc, 640, v4
    v_sub_u32 v5, v100, v4
    v_add_u32 v102, s33, v4
    v_cndmask_b32 v84, v102, v5, vcc
    v_cndmask_b32 v94, 0, v103, vcc
    ds_read_u16 v116, v84
    ds_read_u16 v126, v84 offset:2048
    v_add_u32 v4, 522, v101
    v_subrev_u32 v5, 1280, v4
    v_min_u32 v4, v4, v5
    v_cmp_lt_u32 vcc, 640, v4
    v_sub_u32 v5, v100, v4
    v_add_u32 v102, s33, v4
    v_cndmask_b32 v85, v102, v5, vcc
    v_cndmask_b32 v95, 0, v103, vcc
    ds_read_u16 v117, v85
    ds_read_u16 v127, v85 offset:2048
    s_waitcnt lgkmcnt(2)
    v_add_u32 v4, 768, v101
    v_subrev_u32 v5, 1280, v4
    v_min_u32 v4, v4, v5
    v_cmp_lt_u32 vcc, 640, v4
    v_sub_u32 v5, v100, v4
    v_add_u32 v102, s33, v4
    v_cndmask_b32 v86, v102, v5, vcc
    v_cndmask_b32 v96, 0, v103, vcc
    ds_read_u16 v118, v86
    ds_read_u16 v128, v86 offset:2048
    v_add_u32 v4, 778, v101
    v_subrev_u32 v5, 1280, v4
    v_min_u32 v4, v4, v5
    v_cmp_lt_u32 vcc, 640, v4
    v_sub_u32 v5, v100, v4
    v_add_u32 v102, s33, v4
    v_cndmask_b32 v87, v102, v5, vcc
    v_cndmask_b32 v97, 0, v103, vcc
    ds_read_u16 v119, v87
    ds_read_u16 v129, v87 offset:2048
    v_add_u32 v4, 1024, v101
    v_subrev_u32 v5, 1280, v4
    v_min_u32 v4, v4, v5
    v_cmp_lt_u32 vcc, 640, v4
    v_sub_u32 v5, v100, v4
    v_add_u32 v102, s33, v4
    v_cndmask_b32 v88, v102, v5, vcc
    v_cndmask_b32 v98, 0, v103, vcc
    ds_read_u16 v120, v88
    ds_read_u16 v130, v88 offset:2048
    v_add_u32 v4, 1034, v101
    v_subrev_u32 v5, 1280, v4
    v_min_u32 v4, v4, v5
    v_cmp_lt_u32 vcc, 640, v4
    v_sub_u32 v5, v100, v4
    v_add_u32 v102, s33, v4
    v_cndmask_b32 v89, v102, v5, vcc
    v_cndmask_b32 v99, 0, v103, vcc
    ds_read_u16 v121, v89
    ds_read_u16 v131, v89 offset:2048
    v_subrev_u32 v104, 1280, v104
    v_min_u32 v104, v104, v100
    ds_read_u16 v105, v104
    ds_read_u16 v106, v104 offset:2048
    s_waitcnt lgkmcnt(0)
    v_lshl_or_b32 v208, v122, 16, v112
    v_xor_b32 v208, v90, v208
    v_lshl_or_b32 v209, v123, 16, v113
    v_xor_b32 v209, v91, v209
    v_lshl_or_b32 v210, v124, 16, v114
    v_xor_b32 v210, v92, v210
    v_lshl_or_b32 v211, v125, 16, v115
    v_xor_b32 v211, v93, v211
    v_lshl_or_b32 v212, v126, 16, v116
    v_xor_b32 v212, v94, v212
    v_lshl_or_b32 v213, v127, 16, v117
    v_xor_b32 v213, v95, v213
    v_lshl_or_b32 v214, v128, 16, v118
    v_xor_b32 v214, v96, v214
    v_lshl_or_b32 v215, v129, 16, v119
    v_xor_b32 v215, v97, v215
    v_lshl_or_b32 v216, v130, 16, v120
    v_xor_b32 v216, v98, v216
    v_lshl_or_b32 v217, v131, 16, v121
    v_xor_b32 v217, v99, v217
    v_lshlrev_b32 v112, 16, v112
    v_lshlrev_b32 v122, 16, v122
    v_lshlrev_b32 v105, 16, v105
    v_lshlrev_b32 v106, 16, v106
    v_add_f32 v105, v112, v105
    v_sub_f32 v106, v122, v106
    v_mul_f32 v105, 0.5, v105
    v_mul_f32 v106, 0.5, v106
    v_cvt_pk_bf16_f32 v105, v105, v106
    v_cmp_eq_u32 vcc, 0, v7
    s_nop 1
    v_cndmask_b32 v208, v208, v105, vcc
    s_cmp_lg_u32 s72, 0
    s_nop 2
    s_cbranch_scc1 F_WB1
    s_add_u32 s33, s74, s73
    s_add_u32 s34, s75, s73
    s_add_u32 s34, s34, 2304
    v_mov_b32 v100, s34
    v_mul_u32_u24 v101, 20, v1
    v_bfrev_b32 v103, 1
    v_add_u32 v4, 0, v101
    v_subrev_u32 v5, 1280, v4
    v_min_u32 v4, v4, v5
    v_cmp_lt_u32 vcc, 640, v4
    v_sub_u32 v5, v100, v4
    v_add_u32 v102, s33, v4
    v_cndmask_b32 v80, v102, v5, vcc
    v_cndmask_b32 v90, 0, v103, vcc
    v_add_u32 v104, v100, v4
    ds_read_u16 v112, v80
    ds_read_u16 v122, v80 offset:2048
    v_add_u32 v4, 10, v101
    v_subrev_u32 v5, 1280, v4
    v_min_u32 v4, v4, v5
    v_cmp_lt_u32 vcc, 640, v4
    v_sub_u32 v5, v100, v4
    v_add_u32 v102, s33, v4
    v_cndmask_b32 v81, v102, v5, vcc
    v_cndmask_b32 v91, 0, v103, vcc
    ds_read_u16 v113, v81
    ds_read_u16 v123, v81 offset:2048
    v_add_u32 v4, 768, v101
    v_subrev_u32 v5, 1280, v4
    v_min_u32 v4, v4, v5
    v_cmp_lt_u32 vcc, 640, v4
    v_sub_u32 v5, v100, v4
    v_add_u32 v102, s33, v4
    v_cndmask_b32 v82, v102, v5, vcc
    v_cndmask_b32 v92, 0, v103, vcc
    ds_read_u16 v114, v82
    ds_read_u16 v124, v82 offset:2048
    v_add_u32 v4, 778, v101
    v_subrev_u32 v5, 1280, v4
    v_min_u32 v4, v4, v5
    v_cmp_lt_u32 vcc, 640, v4
    v_sub_u32 v5, v100, v4
    v_add_u32 v102, s33, v4
    v_cndmask_b32 v83, v102, v5, vcc
    v_cndmask_b32 v93, 0, v103, vcc
    ds_read_u16 v115, v83
    ds_read_u16 v125, v83 offset:2048
    v_add_u32 v4, 1024, v101
    v_subrev_u32 v5, 1280, v4
    v_min_u32 v4, v4, v5
    v_cmp_lt_u32 vcc, 640, v4
    v_sub_u32 v5, v100, v4
    v_add_u32 v102, s33, v4
    v_cndmask_b32 v84, v102, v5, vcc
    v_cndmask_b32 v94, 0, v103, vcc
    ds_read_u16 v116, v84
    ds_read_u16 v126, v84 offset:2048
    v_add_u32 v4, 1034, v101
    v_subrev_u32 v5, 1280, v4
    v_min_u32 v4, v4, v5
    v_cmp_lt_u32 vcc, 640, v4
    v_sub_u32 v5, v100, v4
    v_add_u32 v102, s33, v4
    v_cndmask_b32 v85, v102, v5, vcc
    v_cndmask_b32 v95, 0, v103, vcc
    ds_read_u16 v117, v85
    ds_read_u16 v127, v85 offset:2048
    s_waitcnt lgkmcnt(2)
    v_subrev_u32 v104, 1280, v104
    v_min_u32 v104, v104, v100
    ds_read_u16 v105, v104
    ds_read_u16 v106, v104 offset:2048
    s_waitcnt lgkmcnt(0)
    v_lshl_or_b32 v218, v122, 16, v112
    v_xor_b32 v218, v90, v218
    v_lshl_or_b32 v219, v123, 16, v113
    v_xor_b32 v219, v91, v219
    v_lshl_or_b32 v214, v124, 16, v114
    v_xor_b32 v214, v92, v214
    v_lshl_or_b32 v215, v125, 16, v115
    v_xor_b32 v215, v93, v215
    v_lshl_or_b32 v216, v126, 16, v116
    v_xor_b32 v216, v94, v216
    v_lshl_or_b32 v217, v127, 16, v117
    v_xor_b32 v217, v95, v217
    v_lshlrev_b32 v112, 16, v112
    v_lshlrev_b32 v122, 16, v122
    v_lshlrev_b32 v105, 16, v105
    v_lshlrev_b32 v106, 16, v106
    v_add_f32 v105, v112, v105
    v_sub_f32 v106, v122, v106
    v_mul_f32 v105, 0.5, v105
    v_mul_f32 v106, 0.5, v106
    v_cvt_pk_bf16_f32 v105, v105, v106
    v_cmp_eq_u32 vcc, 0, v7
    s_nop 1
    v_cndmask_b32 v218, v218, v105, vcc
    s_nop 4
F_WB1:
    s_setprio 3
    v_lshlrev_b32 v4, 3, v1
    s_add_u32 s32, s76, 0
    buffer_store_dwordx2 v[208:209], v4, s[4:7], s32 offen sc0 sc1
    s_add_u32 s32, s76, 16384
    buffer_store_dwordx2 v[210:211], v4, s[4:7], s32 offen sc0 sc1
    s_add_u32 s32, s76, 32768
    buffer_store_dwordx2 v[212:213], v4, s[4:7], s32 offen sc0 sc1
    s_add_u32 s32, s76, 49152
    buffer_store_dwordx2 v[214:215], v4, s[4:7], s32 offen sc0 sc1
    s_add_u32 s32, s76, 65536
    buffer_store_dwordx2 v[216:217], v4, s[4:7], s32 offen sc0 sc1
    s_add_u32 s32, s76, 2621440
    s_cmp_eq_u32 s72, 0
    s_cselect_b32 s32, s32, 1073741824
    buffer_store_dwordx2 v[218:219], v4, s[4:7], s32 offen sc0 sc1
    s_cmp_eq_u32 s77, 0
    s_cselect_b32 s40, 1073741824, s40
    v_mov_b32 v252, 0
    s_mov_b64 exec, 1
    buffer_atomic_add v252, v10, s[4:7], s40 offen sc0 sc1
    s_mov_b64 exec, -1
    s_lshl_b32 s92, s72, 7
    s_add_u32 s92, s92, 12398592
    v_mov_b32 v156, 1
    s_waitcnt vmcnt(0)
    s_mov_b64 exec, 1
    buffer_atomic_add v156, v10, s[4:7], s92 offen sc1
    s_mov_b64 exec, -1
    s_cmp_eq_u32 s77, 0
    s_cbranch_scc1 F_NOA
    v_cmp_gt_u32 vcc, 64, v252
    s_nop 0
    s_and_b64 vcc, vcc, 1
    s_mov_b32 s89, 0
    s_nop 1
F_FU_L:
    s_cbranch_vccz F_FU_D
    s_add_u32 s89, s89, 1
    s_cmp_ge_u32 s89, 40000
    s_cbranch_scc1 F_FU_D
    s_sleep 4
    v_mov_b32 v252, 0
    s_mov_b64 exec, 1
    buffer_atomic_add v252, v10, s[4:7], s40 offen sc0 sc1
    s_mov_b64 exec, -1
    s_waitcnt vmcnt(0)
    v_cmp_gt_u32 vcc, 64, v252
    s_nop 0
    s_and_b64 vcc, vcc, 1
    s_nop 1
    s_branch F_FU_L
    s_nop 0
F_FU_D:
    s_lshl_b32 s32, s31, 14
    s_cmp_eq_u32 s31, 160
    s_cselect_b32 s32, 0, s32
    s_add_u32 s32, s32, s90
    s_add_u32 s32, s32, 5251072
    buffer_load_dwordx4 v[112:115], v6, s[4:7], s32 offen offset:0 sc1
    buffer_load_dwordx4 v[116:119], v6, s[4:7], s32 offen offset:1024 sc1
    buffer_load_dwordx4 v[120:123], v6, s[4:7], s32 offen offset:2048 sc1
    buffer_load_dwordx4 v[124:127], v6, s[4:7], s32 offen offset:3072 sc1
    s_setprio 0
    ds_read_b128 v[132:135], v11 offset:0
    s_waitcnt lgkmcnt(0)
    s_mov_b32 s89, 0
    s_nop 0
F_G4_L:
    v_min3_u32 v132, v132, v133, v134
    v_min_u32 v132, v132, v135
    v_cmp_gt_u32 vcc, 4, v132
    s_nop 3
    s_cbranch_vccz F_G4_D
    s_add_u32 s89, s89, 1
    s_cmp_ge_u32 s89, 320000
    s_cbranch_scc1 F_G4_D
    s_sleep 2
    ds_read_b128 v[132:135], v11 offset:0
    s_waitcnt lgkmcnt(0)
    s_branch F_G4_L
    s_nop 0
F_G4_D:
    s_waitcnt vmcnt(0)
    s_cmp_lg_u32 s30, 0
    s_cbranch_scc1 F_NSU
    s_and_b32 s33, s29, 31
    s_cmp_lg_u32 s33, 0
    s_cbranch_scc1 F_NSU
    s_lshr_b32 s33, s29, 5
    v_cmp_ne_u32 vcc, s33, v154
    s_nop 1
    v_cndmask_b32 v112, v112, 0, vcc
    v_cndmask_b32 v113, v113, 0, vcc
    v_cndmask_b32 v114, v114, 0, vcc
    v_cndmask_b32 v115, v115, 0, vcc
    v_cndmask_b32 v116, v116, 0, vcc
    v_cndmask_b32 v117, v117, 0, vcc
    v_cndmask_b32 v118, v118, 0, vcc
    v_cndmask_b32 v119, v119, 0, vcc
    v_cndmask_b32 v120, v120, 0, vcc
    v_cndmask_b32 v121, v121, 0, vcc
    v_cndmask_b32 v122, v122, 0, vcc
    v_cndmask_b32 v123, v123, 0, vcc
    v_cndmask_b32 v124, v124, 0, vcc
    v_cndmask_b32 v125, v125, 0, vcc
    v_cndmask_b32 v126, v126, 0, vcc
    v_cndmask_b32 v127, v127, 0, vcc
    s_lshl_b32 s33, s33, 10
    v_xor_b32 v153, s33, v153
    s_nop 4
F_NSU:
    ds_write_b128 v153, v[112:115] offset:20480
    ds_write_b128 v153, v[116:119] offset:20736
    ds_write_b128 v153, v[120:123] offset:22528
    ds_write_b128 v153, v[124:127] offset:22784
    s_waitcnt lgkmcnt(0)
    v_mov_b32 v132, 3
    ds_write_b32 v9, v132
    ds_read_b128 v[132:135], v11 offset:16
    s_waitcnt lgkmcnt(0)
    s_mov_b32 s89, 0
    s_nop 0
F_U_L:
    v_min3_u32 v132, v132, v133, v134
    v_min_u32 v132, v132, v135
    v_cmp_gt_u32 vcc, 3, v132
    s_nop 3
    s_cbranch_vccz F_U_D
    s_add_u32 s89, s89, 1
    s_cmp_ge_u32 s89, 320000
    s_cbranch_scc1 F_U_D
    ds_read_b128 v[132:135], v11 offset:16
    s_waitcnt lgkmcnt(0)
    s_branch F_U_L
    s_nop 0
F_U_D:
    v_lshlrev_b32 v250, 2, v7
    v_lshl_add_u32 v250, v8, 11, v250
    s_lshl_b32 s95, s31, 14
    s_lshl_b32 s33, s24, 7
    s_add_u32 s95, s95, s33
    s_add_u32 s95, s95, 12791808
    s_mul_i32 s41, s31, 205
    s_lshr_b32 s41, s41, 10
    s_and_b32 s41, s41, 31
    s_lshl_b32 s41, s41, 7
    s_add_u32 s41, s41, 12398592
    s_setprio 3
    v_mov_b32 v252, 0
    s_mov_b64 exec, 1
    buffer_atomic_add v252, v10, s[4:7], s41 offen sc0 sc1
    s_mov_b64 exec, -1
    s_setprio 0
    ds_read_b128 v[80:83], v6 offset:20480
    ds_read_b128 v[84:87], v6 offset:21504
    ds_read_b128 v[88:91], v6 offset:22528
    ds_read_b128 v[92:95], v6 offset:23552
    ds_read_b128 v[96:99], v6 offset:24576
    ds_read_b128 v[100:103], v6 offset:25600
    ds_read_b128 v[104:107], v6 offset:26624
    ds_read_b128 v[108:111], v6 offset:27648
    s_waitcnt lgkmcnt(6)
    v_mfma_f32_32x32x16_bf16 v[112:127], v[80:83], v[16:19], 0
    v_mfma_f32_32x32x16_bf16 v[128:143], v[84:87], v[16:19], 0
    v_mfma_f32_32x32x16_bf16 v[144:159], v[80:83], v[48:51], 0
    v_mfma_f32_32x32x16_bf16 v[112:127], v[84:87], v[48:51], v[112:127]
    ds_read_b128 v[80:83], v6 offset:28672
    ds_read_b128 v[84:87], v6 offset:29696
    s_waitcnt lgkmcnt(6)
    v_mfma_f32_32x32x16_bf16 v[112:127], v[88:91], v[20:23], v[112:127]
    v_mfma_f32_32x32x16_bf16 v[128:143], v[92:95], v[20:23], v[128:143]
    v_mfma_f32_32x32x16_bf16 v[144:159], v[88:91], v[52:55], v[144:159]
    v_mfma_f32_32x32x16_bf16 v[112:127], v[92:95], v[52:55], v[112:127]
    ds_read_b128 v[88:91], v6 offset:30720
    ds_read_b128 v[92:95], v6 offset:31744
    s_waitcnt lgkmcnt(6)
    v_mfma_f32_32x32x16_bf16 v[112:127], v[96:99], v[24:27], v[112:127]
    v_mfma_f32_32x32x16_bf16 v[128:143], v[100:103], v[24:27], v[128:143]
    v_mfma_f32_32x32x16_bf16 v[144:159], v[96:99], v[56:59], v[144:159]
    v_mfma_f32_32x32x16_bf16 v[112:127], v[100:103], v[56:59], v[112:127]
    ds_read_b128 v[96:99], v6 offset:32768
    ds_read_b128 v[100:103], v6 offset:33792
    s_waitcnt lgkmcnt(6)
    v_mfma_f32_32x32x16_bf16 v[112:127], v[104:107], v[28:31], v[112:127]
    v_mfma_f32_32x32x16_bf16 v[128:143], v[108:111], v[28:31], v[128:143]
    v_mfma_f32_32x32x16_bf16 v[144:159], v[104:107], v[60:63], v[144:159]
    v_mfma_f32_32x32x16_bf16 v[112:127], v[108:111], v[60:63], v[112:127]
    s_waitcnt vmcnt(0)
    v_cmp_gt_u32 vcc, 32, v252
    s_nop 0
    s_and_b64 vcc, vcc, 1
    s_mov_b32 s89, 0
    s_nop 6
F_FW_L:
    s_cbranch_vccz F_FW_D
    s_add_u32 s89, s89, 1
    s_cmp_ge_u32 s89, 40000
    s_cbranch_scc1 F_FW_D
    s_sleep 2
    v_mov_b32 v252, 0
    s_mov_b64 exec, 1
    buffer_atomic_add v252, v10, s[4:7], s41 offen sc0 sc1
    s_mov_b64 exec, -1
    s_waitcnt vmcnt(0)
    v_cmp_gt_u32 vcc, 32, v252
    s_nop 0
    s_and_b64 vcc, vcc, 1
    s_nop 1
    s_branch F_FW_L
    s_nop 0
F_FW_D:
    s_setprio 3
    ds_read_b128 v[104:107], v6 offset:34816
    ds_read_b128 v[108:111], v6 offset:35840
    s_waitcnt lgkmcnt(6)
    v_mfma_f32_32x32x16_bf16 v[112:127], v[80:83], v[32:35], v[112:127]
    buffer_load_dword v224, v250, s[4:7], s95 offen offset:0 sc1
    v_mfma_f32_32x32x16_bf16 v[128:143], v[84:87], v[32:35], v[128:143]
    buffer_load_dword v225, v250, s[4:7], s95 offen offset:512 sc1
    v_mfma_f32_32x32x16_bf16 v[144:159], v[80:83], v[64:67], v[144:159]
    buffer_load_dword v226, v250, s[4:7], s95 offen offset:1024 sc1
    v_mfma_f32_32x32x16_bf16 v[112:127], v[84:87], v[64:67], v[112:127]
    buffer_load_dword v227, v250, s[4:7], s95 offen offset:1536 sc1
    s_waitcnt lgkmcnt(4)
    v_mfma_f32_32x32x16_bf16 v[112:127], v[88:91], v[36:39], v[112:127]
    s_add_u32 s95, s95, 4096
    buffer_load_dword v228, v250, s[4:7], s95 offen offset:0 sc1
    v_mfma_f32_32x32x16_bf16 v[128:143], v[92:95], v[36:39], v[128:143]
    buffer_load_dword v229, v250, s[4:7], s95 offen offset:512 sc1
    v_mfma_f32_32x32x16_bf16 v[144:159], v[88:91], v[68:71], v[144:159]
    buffer_load_dword v230, v250, s[4:7], s95 offen offset:1024 sc1
    v_mfma_f32_32x32x16_bf16 v[112:127], v[92:95], v[68:71], v[112:127]
    buffer_load_dword v231, v250, s[4:7], s95 offen offset:1536 sc1
    s_waitcnt lgkmcnt(2)
    v_mfma_f32_32x32x16_bf16 v[112:127], v[96:99], v[40:43], v[112:127]
    s_add_u32 s95, s95, 4096
    buffer_load_dword v232, v250, s[4:7], s95 offen offset:0 sc1
    v_mfma_f32_32x32x16_bf16 v[128:143], v[100:103], v[40:43], v[128:143]
    buffer_load_dword v233, v250, s[4:7], s95 offen offset:512 sc1
    v_mfma_f32_32x32x16_bf16 v[144:159], v[96:99], v[72:75], v[144:159]
    buffer_load_dword v234, v250, s[4:7], s95 offen offset:1024 sc1
    v_mfma_f32_32x32x16_bf16 v[112:127], v[100:103], v[72:75], v[112:127]
    buffer_load_dword v235, v250, s[4:7], s95 offen offset:1536 sc1
    s_waitcnt lgkmcnt(0)
    v_mfma_f32_32x32x16_bf16 v[112:127], v[104:107], v[44:47], v[112:127]
    s_add_u32 s95, s95, 4096
    buffer_load_dword v236, v250, s[4:7], s95 offen offset:0 sc1
    v_mfma_f32_32x32x16_bf16 v[128:143], v[108:111], v[44:47], v[128:143]
    buffer_load_dword v237, v250, s[4:7], s95 offen offset:512 sc1
    v_mfma_f32_32x32x16_bf16 v[144:159], v[104:107], v[76:79], v[144:159]
    buffer_load_dword v238, v250, s[4:7], s95 offen offset:1024 sc1
    v_mfma_f32_32x32x16_bf16 v[112:127], v[108:111], v[76:79], v[112:127]
    buffer_load_dword v239, v250, s[4:7], s95 offen offset:1536 sc1
    s_setprio 0
    s_mul_i32 s41, s28, 5
    s_add_u32 s41, s41, 80
    s_lshl_b32 s41, s41, 2
    s_add_u32 s41, s41, s24
    s_lshl_b32 s41, s41, 7
    s_add_u32 s41, s41, 12337152
    v_mov_b32 v252, 0
    v_lshlrev_b32 v4, 9, v1
    s_mov_b64 exec, 31
    buffer_atomic_add v252, v4, s[4:7], s41 offen sc0 sc1
    s_mov_b64 exec, -1
    v_pk_add_f32 v[128:129], v[128:129], v[144:145] neg_lo:[0,1] neg_hi:[0,1]
    v_pk_add_f32 v[130:131], v[130:131], v[146:147] neg_lo:[0,1] neg_hi:[0,1]
    v_pk_add_f32 v[132:133], v[132:133], v[148:149] neg_lo:[0,1] neg_hi:[0,1]
    v_pk_add_f32 v[134:135], v[134:135], v[150:151] neg_lo:[0,1] neg_hi:[0,1]
    v_pk_add_f32 v[136:137], v[136:137], v[152:153] neg_lo:[0,1] neg_hi:[0,1]
    v_pk_add_f32 v[138:139], v[138:139], v[154:155] neg_lo:[0,1] neg_hi:[0,1]
    v_pk_add_f32 v[140:141], v[140:141], v[156:157] neg_lo:[0,1] neg_hi:[0,1]
    v_pk_add_f32 v[142:143], v[142:143], v[158:159] neg_lo:[0,1] neg_hi:[0,1]
    v_cvt_pk_bf16_f32 v88, v128, v129
    v_cvt_pk_bf16_f32 v89, v130, v131
    v_cvt_pk_bf16_f32 v90, v132, v133
    v_cvt_pk_bf16_f32 v91, v134, v135
    v_cvt_pk_bf16_f32 v92, v136, v137
    v_cvt_pk_bf16_f32 v93, v138, v139
    v_cvt_pk_bf16_f32 v94, v140, v141
    v_cvt_pk_bf16_f32 v95, v142, v143
    v_cvt_pk_bf16_f32 v80, v112, v113
    v_cvt_pk_bf16_f32 v81, v114, v115
    v_cvt_pk_bf16_f32 v82, v116, v117
    v_cvt_pk_bf16_f32 v83, v118, v119
    v_cvt_pk_bf16_f32 v84, v120, v121
    v_cvt_pk_bf16_f32 v85, v122, v123
    v_cvt_pk_bf16_f32 v86, v124, v125
    v_cvt_pk_bf16_f32 v87, v126, v127
    v_mfma_f32_32x32x16_bf16 v[112:127], v[168:171], v[88:91], 0
    v_mfma_f32_32x32x16_bf16 v[128:143], v[160:163], v[88:91], 0
    v_mfma_f32_32x32x16_bf16 v[112:127], v[172:175], v[92:95], v[112:127]
    v_mfma_f32_32x32x16_bf16 v[128:143], v[164:167], v[92:95], v[128:143]
    v_mfma_f32_32x32x16_bf16 v[112:127], v[160:163], v[80:83], v[112:127]
    v_mfma_f32_32x32x16_bf16 v[128:143], v[176:179], v[80:83], v[128:143]
    v_mfma_f32_32x32x16_bf16 v[112:127], v[164:167], v[84:87], v[112:127]
    v_mfma_f32_32x32x16_bf16 v[128:143], v[180:183], v[84:87], v[128:143]
    s_waitcnt vmcnt(0)
    v_lshlrev_b32 v208, 16, v224
    v_and_b32 v224, 0xffff0000, v224
    v_lshlrev_b32 v209, 16, v225
    v_and_b32 v225, 0xffff0000, v225
    v_lshlrev_b32 v210, 16, v226
    v_and_b32 v226, 0xffff0000, v226
    v_lshlrev_b32 v211, 16, v227
    v_and_b32 v227, 0xffff0000, v227
    v_lshlrev_b32 v212, 16, v228
    v_and_b32 v228, 0xffff0000, v228
    v_lshlrev_b32 v213, 16, v229
    v_and_b32 v229, 0xffff0000, v229
    v_lshlrev_b32 v214, 16, v230
    v_and_b32 v230, 0xffff0000, v230
    v_lshlrev_b32 v215, 16, v231
    v_and_b32 v231, 0xffff0000, v231
    v_lshlrev_b32 v216, 16, v232
    v_and_b32 v232, 0xffff0000, v232
    v_lshlrev_b32 v217, 16, v233
    v_and_b32 v233, 0xffff0000, v233
    v_lshlrev_b32 v218, 16, v234
    v_and_b32 v234, 0xffff0000, v234
    v_lshlrev_b32 v219, 16, v235
    v_and_b32 v235, 0xffff0000, v235
    v_lshlrev_b32 v220, 16, v236
    v_and_b32 v236, 0xffff0000, v236
    v_lshlrev_b32 v221, 16, v237
    v_and_b32 v237, 0xffff0000, v237
    v_lshlrev_b32 v222, 16, v238
    v_and_b32 v238, 0xffff0000, v238
    v_lshlrev_b32 v223, 16, v239
    v_and_b32 v239, 0xffff0000, v239
    v_pk_mul_f32 v[144:145], v[112:113], v[208:209]
    v_pk_mul_f32 v[112:113], v[112:113], v[224:225]
    v_pk_mul_f32 v[146:147], v[114:115], v[210:211]
    v_pk_mul_f32 v[114:115], v[114:115], v[226:227]
    v_pk_mul_f32 v[148:149], v[116:117], v[212:213]
    v_pk_mul_f32 v[116:117], v[116:117], v[228:229]
    v_pk_mul_f32 v[150:151], v[118:119], v[214:215]
    v_pk_mul_f32 v[118:119], v[118:119], v[230:231]
    v_pk_mul_f32 v[152:153], v[120:121], v[216:217]
    v_pk_mul_f32 v[120:121], v[120:121], v[232:233]
    v_pk_mul_f32 v[154:155], v[122:123], v[218:219]
    v_pk_mul_f32 v[122:123], v[122:123], v[234:235]
    v_pk_mul_f32 v[156:157], v[124:125], v[220:221]
    v_pk_mul_f32 v[124:125], v[124:125], v[236:237]
    v_pk_mul_f32 v[158:159], v[126:127], v[222:223]
    v_pk_mul_f32 v[126:127], v[126:127], v[238:239]
    v_pk_fma_f32 v[144:145], v[128:129], v[224:225], v[144:145] neg_lo:[1,0,0] neg_hi:[1,0,0]
    v_pk_fma_f32 v[112:113], v[128:129], v[208:209], v[112:113]
    v_pk_fma_f32 v[146:147], v[130:131], v[226:227], v[146:147] neg_lo:[1,0,0] neg_hi:[1,0,0]
    v_pk_fma_f32 v[114:115], v[130:131], v[210:211], v[114:115]
    v_pk_fma_f32 v[148:149], v[132:133], v[228:229], v[148:149] neg_lo:[1,0,0] neg_hi:[1,0,0]
    v_pk_fma_f32 v[116:117], v[132:133], v[212:213], v[116:117]
    v_pk_fma_f32 v[150:151], v[134:135], v[230:231], v[150:151] neg_lo:[1,0,0] neg_hi:[1,0,0]
    v_pk_fma_f32 v[118:119], v[134:135], v[214:215], v[118:119]
    v_pk_fma_f32 v[152:153], v[136:137], v[232:233], v[152:153] neg_lo:[1,0,0] neg_hi:[1,0,0]
    v_pk_fma_f32 v[120:121], v[136:137], v[216:217], v[120:121]
    v_pk_fma_f32 v[154:155], v[138:139], v[234:235], v[154:155] neg_lo:[1,0,0] neg_hi:[1,0,0]
    v_pk_fma_f32 v[122:123], v[138:139], v[218:219], v[122:123]
    v_pk_fma_f32 v[156:157], v[140:141], v[236:237], v[156:157] neg_lo:[1,0,0] neg_hi:[1,0,0]
    v_pk_fma_f32 v[124:125], v[140:141], v[220:221], v[124:125]
    v_pk_fma_f32 v[158:159], v[142:143], v[238:239], v[158:159] neg_lo:[1,0,0] neg_hi:[1,0,0]
    v_pk_fma_f32 v[126:127], v[142:143], v[222:223], v[126:127]
    v_cvt_pk_bf16_f32 v96, v144, v145
    v_cvt_pk_bf16_f32 v97, v146, v147
    v_cvt_pk_bf16_f32 v98, v148, v149
    v_cvt_pk_bf16_f32 v99, v150, v151
    v_cvt_pk_bf16_f32 v100, v152, v153
    v_cvt_pk_bf16_f32 v101, v154, v155
    v_cvt_pk_bf16_f32 v102, v156, v157
    v_cvt_pk_bf16_f32 v103, v158, v159
    v_cvt_pk_bf16_f32 v104, v112, v113
    v_cvt_pk_bf16_f32 v105, v114, v115
    v_cvt_pk_bf16_f32 v106, v116, v117
    v_cvt_pk_bf16_f32 v107, v118, v119
    v_cvt_pk_bf16_f32 v108, v120, v121
    v_cvt_pk_bf16_f32 v109, v122, v123
    v_cvt_pk_bf16_f32 v110, v124, v125
    v_cvt_pk_bf16_f32 v111, v126, v127
    v_mfma_f32_32x32x16_bf16 v[112:127], v[96:99], v[184:187], 0
    v_mfma_f32_32x32x16_bf16 v[128:143], v[96:99], v[192:195], 0
    v_mfma_f32_32x32x16_bf16 v[112:127], v[100:103], v[188:191], v[112:127]
    v_mfma_f32_32x32x16_bf16 v[128:143], v[100:103], v[196:199], v[128:143]
    v_mfma_f32_32x32x16_bf16 v[112:127], v[104:107], v[200:203], v[112:127]
    v_mfma_f32_32x32x16_bf16 v[128:143], v[104:107], v[184:187], v[128:143]
    v_mfma_f32_32x32x16_bf16 v[112:127], v[108:111], v[204:207], v[112:127]
    v_mfma_f32_32x32x16_bf16 v[128:143], v[108:111], v[188:191], v[128:143]
    ds_read_b128 v[144:147], v11 offset:0
    s_waitcnt lgkmcnt(0)
    s_mov_b32 s89, 0
    s_nop 8
F_GX_L:
    v_min3_u32 v144, v144, v145, v146
    v_min_u32 v144, v144, v147
    v_cmp_gt_u32 vcc, 6, v144
    s_nop 3
    s_cbranch_vccz F_GX_D
    s_add_u32 s89, s89, 1
    s_cmp_ge_u32 s89, 320000
    s_cbranch_scc1 F_GX_D
    s_sleep 2
    ds_read_b128 v[144:147], v11 offset:0
    s_waitcnt lgkmcnt(0)
    s_branch F_GX_L
    s_nop 0
F_GX_D:
    v_add_u32 v12, s90, v6
    v_cvt_pk_bf16_f32 v80, v112, v113
    v_cvt_pk_bf16_f32 v81, v114, v115
    v_cvt_pk_bf16_f32 v82, v116, v117
    v_cvt_pk_bf16_f32 v83, v118, v119
    v_cvt_pk_bf16_f32 v84, v120, v121
    v_cvt_pk_bf16_f32 v85, v122, v123
    v_cvt_pk_bf16_f32 v86, v124, v125
    v_cvt_pk_bf16_f32 v87, v126, v127
    ds_write_b128 v12, v[80:83] offset:0
    ds_write_b128 v12, v[84:87] offset:2048
    v_cvt_pk_bf16_f32 v88, v128, v129
    v_cvt_pk_bf16_f32 v89, v130, v131
    v_cvt_pk_bf16_f32 v90, v132, v133
    v_cvt_pk_bf16_f32 v91, v134, v135
    v_cvt_pk_bf16_f32 v92, v136, v137
    v_cvt_pk_bf16_f32 v93, v138, v139
    v_cvt_pk_bf16_f32 v94, v140, v141
    v_cvt_pk_bf16_f32 v95, v142, v143
    ds_write_b128 v12, v[88:91] offset:1024
    ds_write_b128 v12, v[92:95] offset:3072
    s_waitcnt lgkmcnt(0)
    v_mov_b32 v144, 4
    ds_write_b32 v9, v144
    ds_read_b128 v[144:147], v11 offset:16
    s_waitcnt lgkmcnt(0)
    s_mov_b32 s89, 0
    s_nop 0
F_X_L:
    v_min3_u32 v144, v144, v145, v146
    v_min_u32 v144, v144, v147
    v_cmp_gt_u32 vcc, 4, v144
    s_nop 3
    s_cbranch_vccz F_X_D
    s_add_u32 s89, s89, 1
    s_cmp_ge_u32 s89, 320000
    s_cbranch_scc1 F_X_D
    ds_read_b128 v[144:147], v11 offset:16
    s_waitcnt lgkmcnt(0)
    s_branch F_X_L
    s_nop 0
F_X_D:
    ds_read_b128 v[80:83], v6 offset:0
    ds_read_b128 v[84:87], v6 offset:1024
    ds_read_b128 v[88:91], v6 offset:2048
    ds_read_b128 v[92:95], v6 offset:3072
    ds_read_b128 v[96:99], v6 offset:4096
    ds_read_b128 v[100:103], v6 offset:5120
    ds_read_b128 v[104:107], v6 offset:6144
    ds_read_b128 v[108:111], v6 offset:7168
    s_waitcnt lgkmcnt(6)
    v_mfma_f32_32x32x16_bf16 v[112:127], v[80:83], v[16:19], 0
    v_mfma_f32_32x32x16_bf16 v[128:143], v[84:87], v[16:19], 0
    v_mfma_f32_32x32x16_bf16 v[144:159], v[84:87], v[48:51], 0
    v_mfma_f32_32x32x16_bf16 v[128:143], v[80:83], v[48:51], v[128:143]
    ds_read_b128 v[80:83], v6 offset:8192
    ds_read_b128 v[84:87], v6 offset:9216
    s_waitcnt lgkmcnt(6)
    v_mfma_f32_32x32x16_bf16 v[112:127], v[88:91], v[20:23], v[112:127]
    v_mfma_f32_32x32x16_bf16 v[128:143], v[92:95], v[20:23], v[128:143]
    v_mfma_f32_32x32x16_bf16 v[144:159], v[92:95], v[52:55], v[144:159]
    v_mfma_f32_32x32x16_bf16 v[128:143], v[88:91], v[52:55], v[128:143]
    ds_read_b128 v[88:91], v6 offset:10240
    ds_read_b128 v[92:95], v6 offset:11264
    s_waitcnt lgkmcnt(6)
    v_mfma_f32_32x32x16_bf16 v[112:127], v[96:99], v[24:27], v[112:127]
    v_mfma_f32_32x32x16_bf16 v[128:143], v[100:103], v[24:27], v[128:143]
    v_mfma_f32_32x32x16_bf16 v[144:159], v[100:103], v[56:59], v[144:159]
    v_mfma_f32_32x32x16_bf16 v[128:143], v[96:99], v[56:59], v[128:143]
    ds_read_b128 v[96:99], v6 offset:12288
    ds_read_b128 v[100:103], v6 offset:13312
    s_waitcnt lgkmcnt(6)
    v_mfma_f32_32x32x16_bf16 v[112:127], v[104:107], v[28:31], v[112:127]
    v_mfma_f32_32x32x16_bf16 v[128:143], v[108:111], v[28:31], v[128:143]
    v_mfma_f32_32x32x16_bf16 v[144:159], v[108:111], v[60:63], v[144:159]
    v_mfma_f32_32x32x16_bf16 v[128:143], v[104:107], v[60:63], v[128:143]
    ds_read_b128 v[104:107], v6 offset:14336
    ds_read_b128 v[108:111], v6 offset:15360
    s_waitcnt lgkmcnt(6)
    v_mfma_f32_32x32x16_bf16 v[112:127], v[80:83], v[32:35], v[112:127]
    v_mfma_f32_32x32x16_bf16 v[128:143], v[84:87], v[32:35], v[128:143]
    v_mfma_f32_32x32x16_bf16 v[144:159], v[84:87], v[64:67], v[144:159]
    v_mfma_f32_32x32x16_bf16 v[128:143], v[80:83], v[64:67], v[128:143]
    s_waitcnt lgkmcnt(4)
    v_mfma_f32_32x32x16_bf16 v[112:127], v[88:91], v[36:39], v[112:127]
    v_mfma_f32_32x32x16_bf16 v[128:143], v[92:95], v[36:39], v[128:143]
    v_mfma_f32_32x32x16_bf16 v[144:159], v[92:95], v[68:71], v[144:159]
    v_mfma_f32_32x32x16_bf16 v[128:143], v[88:91], v[68:71], v[128:143]
    s_waitcnt lgkmcnt(2)
    v_mfma_f32_32x32x16_bf16 v[112:127], v[96:99], v[40:43], v[112:127]
    v_mfma_f32_32x32x16_bf16 v[128:143], v[100:103], v[40:43], v[128:143]
    v_mfma_f32_32x32x16_bf16 v[144:159], v[100:103], v[72:75], v[144:159]
    v_mfma_f32_32x32x16_bf16 v[128:143], v[96:99], v[72:75], v[128:143]
    s_waitcnt lgkmcnt(0)
    v_mfma_f32_32x32x16_bf16 v[112:127], v[104:107], v[44:47], v[112:127]
    v_mfma_f32_32x32x16_bf16 v[128:143], v[108:111], v[44:47], v[128:143]
    v_mfma_f32_32x32x16_bf16 v[144:159], v[108:111], v[76:79], v[144:159]
    v_mfma_f32_32x32x16_bf16 v[128:143], v[104:107], v[76:79], v[128:143]
    v_lshlrev_b32 v4, 2, v7
    v_lshl_add_u32 v4, v8, 11, v4
    s_lshl_b32 s32, s31, 14
    s_lshl_b32 s33, s24, 7
    s_add_u32 s32, s32, s33
    s_add_u32 s32, s32, 7872512
    s_nop 4
    v_pk_add_f32 v[112:113], v[112:113], v[144:145] neg_lo:[0,1] neg_hi:[0,1]
    v_pk_add_f32 v[114:115], v[114:115], v[146:147] neg_lo:[0,1] neg_hi:[0,1]
    v_pk_add_f32 v[116:117], v[116:117], v[148:149] neg_lo:[0,1] neg_hi:[0,1]
    v_pk_add_f32 v[118:119], v[118:119], v[150:151] neg_lo:[0,1] neg_hi:[0,1]
    v_pk_add_f32 v[120:121], v[120:121], v[152:153] neg_lo:[0,1] neg_hi:[0,1]
    v_pk_add_f32 v[122:123], v[122:123], v[154:155] neg_lo:[0,1] neg_hi:[0,1]
    v_pk_add_f32 v[124:125], v[124:125], v[156:157] neg_lo:[0,1] neg_hi:[0,1]
    v_pk_add_f32 v[126:127], v[126:127], v[158:159] neg_lo:[0,1] neg_hi:[0,1]
    s_setprio 3
    v_cvt_pk_bf16_f32 v144, v112, v128
    buffer_store_dword v144, v4, s[4:7], s32 offen offset:0 sc0 sc1
    v_cvt_pk_bf16_f32 v145, v113, v129
    buffer_store_dword v145, v4, s[4:7], s32 offen offset:512 sc0 sc1
    v_cvt_pk_bf16_f32 v146, v114, v130
    buffer_store_dword v146, v4, s[4:7], s32 offen offset:1024 sc0 sc1
    v_cvt_pk_bf16_f32 v147, v115, v131
    buffer_store_dword v147, v4, s[4:7], s32 offen offset:1536 sc0 sc1
    s_add_u32 s32, s32, 4096
    v_cvt_pk_bf16_f32 v148, v116, v132
    buffer_store_dword v148, v4, s[4:7], s32 offen offset:0 sc0 sc1
    v_cvt_pk_bf16_f32 v149, v117, v133
    buffer_store_dword v149, v4, s[4:7], s32 offen offset:512 sc0 sc1
    v_cvt_pk_bf16_f32 v150, v118, v134
    buffer_store_dword v150, v4, s[4:7], s32 offen offset:1024 sc0 sc1
    v_cvt_pk_bf16_f32 v151, v119, v135
    buffer_store_dword v151, v4, s[4:7], s32 offen offset:1536 sc0 sc1
    s_add_u32 s32, s32, 4096
    v_cvt_pk_bf16_f32 v152, v120, v136
    buffer_store_dword v152, v4, s[4:7], s32 offen offset:0 sc0 sc1
    v_cvt_pk_bf16_f32 v153, v121, v137
    buffer_store_dword v153, v4, s[4:7], s32 offen offset:512 sc0 sc1
    v_cvt_pk_bf16_f32 v154, v122, v138
    buffer_store_dword v154, v4, s[4:7], s32 offen offset:1024 sc0 sc1
    v_cvt_pk_bf16_f32 v155, v123, v139
    buffer_store_dword v155, v4, s[4:7], s32 offen offset:1536 sc0 sc1
    s_add_u32 s32, s32, 4096
    v_cvt_pk_bf16_f32 v156, v124, v140
    buffer_store_dword v156, v4, s[4:7], s32 offen offset:0 sc0 sc1
    v_cvt_pk_bf16_f32 v157, v125, v141
    buffer_store_dword v157, v4, s[4:7], s32 offen offset:512 sc0 sc1
    v_cvt_pk_bf16_f32 v158, v126, v142
    buffer_store_dword v158, v4, s[4:7], s32 offen offset:1024 sc0 sc1
    v_cvt_pk_bf16_f32 v159, v127, v143
    buffer_store_dword v159, v4, s[4:7], s32 offen offset:1536 sc0 sc1
    s_setprio 0
    v_cmp_gt_u32 vcc, 20, v252
    s_nop 0
    s_and_b64 vcc, vcc, 31
    s_mov_b32 s89, 0
    s_nop 1
F_FC_L:
    s_cbranch_vccz F_FC_D
    s_add_u32 s89, s89, 1
    s_cmp_ge_u32 s89, 40000
    s_cbranch_scc1 F_FC_D
    s_sleep 8
    v_mov_b32 v252, 0
    v_lshlrev_b32 v4, 9, v1
    s_mov_b64 exec, 31
    buffer_atomic_add v252, v4, s[4:7], s41 offen sc0 sc1
    s_mov_b64 exec, -1
    s_waitcnt vmcnt(0)
    v_cmp_gt_u32 vcc, 20, v252
    s_nop 0
    s_and_b64 vcc, vcc, 31
    s_nop 1
    s_branch F_FC_L
    s_nop 0
F_FC_D:
    s_mul_i32 s73, s28, 204800
    s_mul_i32 s33, s42, 5120
    s_add_u32 s73, s73, s33
    s_add_u32 s73, s73, 10510336
    s_add_u32 s96, s73, 0
    buffer_load_dwordx4 v[160:163], v6, s[4:7], s96 offen offset:0 sc1
    buffer_load_dwordx4 v[164:167], v6, s[4:7], s96 offen offset:1024 sc1
    buffer_load_dwordx4 v[168:171], v6, s[4:7], s96 offen offset:2048 sc1
    buffer_load_dwordx4 v[172:175], v6, s[4:7], s96 offen offset:3072 sc1
    s_add_u32 s96, s96, 4096
    buffer_load_dwordx4 v[176:179], v6, s[4:7], s96 offen offset:0 sc1
    s_add_u32 s96, s73, 40960
    buffer_load_dwordx4 v[180:183], v6, s[4:7], s96 offen offset:0 sc1
    buffer_load_dwordx4 v[184:187], v6, s[4:7], s96 offen offset:1024 sc1
    buffer_load_dwordx4 v[188:191], v6, s[4:7], s96 offen offset:2048 sc1
    buffer_load_dwordx4 v[192:195], v6, s[4:7], s96 offen offset:3072 sc1
    s_add_u32 s96, s96, 4096
    buffer_load_dwordx4 v[196:199], v6, s[4:7], s96 offen offset:0 sc1
    s_mul_i32 s94, s31, 205
    s_lshr_b32 s94, s94, 12
    s_and_b32 s94, s94, 7
    s_lshl_b32 s94, s94, 2
    s_add_u32 s94, s94, s24
    s_add_u32 s94, s94, 48
    s_lshl_b32 s94, s94, 2
    s_lshl_b32 s94, s94, 7
    s_add_u32 s94, s94, 12337152
    s_branch F_J
    s_nop 0
F_NOA:
    s_setprio 0
    s_mul_i32 s41, s28, 5
    s_add_u32 s41, s41, 80
    s_lshl_b32 s41, s41, 2
    s_add_u32 s41, s41, s24
    s_lshl_b32 s41, s41, 7
    s_add_u32 s41, s41, 12337152
    s_cmp_lt_u32 s35, 24
    s_cbranch_scc1 F_NOG
    v_lshlrev_b32 v4, 4, v3
    global_load_dwordx4 v[40:43], v4, s[60:61] offset:0
    global_load_dwordx4 v[44:47], v4, s[60:61] offset:256
    global_load_dwordx4 v[48:51], v4, s[60:61] offset:512
    global_load_dwordx4 v[52:55], v4, s[60:61] offset:768
    global_load_dwordx4 v[56:59], v4, s[60:61] offset:1024
    v_mul_u32_u24 v5, 1280, v2
    v_add_u32 v5, v5, v4
    s_mul_i32 s32, s94, 1280
    buffer_load_dwordx4 v[60:63], v5, s[8:11], s32 offen offset:0
    buffer_load_dwordx4 v[64:67], v5, s[8:11], s32 offen offset:256
    buffer_load_dwordx4 v[68:71], v5, s[8:11], s32 offen offset:512
    buffer_load_dwordx4 v[72:75], v5, s[8:11], s32 offen offset:768
    buffer_load_dwordx4 v[76:79], v5, s[8:11], s32 offen offset:1024
    s_add_u32 s32, s32, 5120
    buffer_load_dwordx4 v[80:83], v5, s[8:11], s32 offen offset:0
    buffer_load_dwordx4 v[84:87], v5, s[8:11], s32 offen offset:256
    buffer_load_dwordx4 v[88:91], v5, s[8:11], s32 offen offset:512
    buffer_load_dwordx4 v[92:95], v5, s[8:11], s32 offen offset:768
    buffer_load_dwordx4 v[96:99], v5, s[8:11], s32 offen offset:1024
    v_mov_b32 v100, 0
    v_mov_b32 v101, s43
    v_mov_b32 v102, 0
    v_mov_b32 v103, s43
    s_waitcnt vmcnt(5)
    v_dot2c_f32_bf16 v100, v60, v40
    v_dot2c_f32_bf16 v100, v61, v41
    v_dot2c_f32_bf16 v100, v62, v42
    v_dot2c_f32_bf16 v100, v63, v43
    v_dot2c_f32_bf16 v100, v64, v44
    v_dot2c_f32_bf16 v100, v65, v45
    v_dot2c_f32_bf16 v100, v66, v46
    v_dot2c_f32_bf16 v100, v67, v47
    v_dot2c_f32_bf16 v100, v68, v48
    v_dot2c_f32_bf16 v100, v69, v49
    v_dot2c_f32_bf16 v100, v70, v50
    v_dot2c_f32_bf16 v100, v71, v51
    v_dot2c_f32_bf16 v100, v72, v52
    v_dot2c_f32_bf16 v100, v73, v53
    v_dot2c_f32_bf16 v100, v74, v54
    v_dot2c_f32_bf16 v100, v75, v55
    v_dot2c_f32_bf16 v100, v76, v56
    v_dot2c_f32_bf16 v100, v77, v57
    v_dot2c_f32_bf16 v100, v78, v58
    v_dot2c_f32_bf16 v100, v79, v59
    s_waitcnt vmcnt(0)
    v_dot2c_f32_bf16 v102, v80, v40
    v_dot2c_f32_bf16 v102, v81, v41
    v_dot2c_f32_bf16 v102, v82, v42
    v_dot2c_f32_bf16 v102, v83, v43
    v_dot2c_f32_bf16 v102, v84, v44
    v_dot2c_f32_bf16 v102, v85, v45
    v_dot2c_f32_bf16 v102, v86, v46
    v_dot2c_f32_bf16 v102, v87, v47
    v_dot2c_f32_bf16 v102, v88, v48
    v_dot2c_f32_bf16 v102, v89, v49
    v_dot2c_f32_bf16 v102, v90, v50
    v_dot2c_f32_bf16 v102, v91, v51
    v_dot2c_f32_bf16 v102, v92, v52
    v_dot2c_f32_bf16 v102, v93, v53
    v_dot2c_f32_bf16 v102, v94, v54
    v_dot2c_f32_bf16 v102, v95, v55
    v_dot2c_f32_bf16 v102, v96, v56
    v_dot2c_f32_bf16 v102, v97, v57
    v_dot2c_f32_bf16 v102, v98, v58
    v_dot2c_f32_bf16 v102, v99, v59
    v_add_f32_dpp v100, v100, v100 row_ror:8 row_mask:0xf bank_mask:0xf
    s_nop 1
    v_add_f32_dpp v102, v102, v102 row_ror:8 row_mask:0xf bank_mask:0xf
    v_add_f32_dpp v100, v100, v100 row_ror:4 row_mask:0xf bank_mask:0xf
    s_nop 0
    v_add_f32_dpp v102, v102, v102 row_ror:4 row_mask:0xf bank_mask:0xf
    v_add_f32_dpp v100, v100, v100 row_ror:2 row_mask:0xf bank_mask:0xf
    s_nop 0
    v_add_f32_dpp v102, v102, v102 row_ror:2 row_mask:0xf bank_mask:0xf
    v_add_f32_dpp v100, v100, v100 row_ror:1 row_mask:0xf bank_mask:0xf
    s_nop 0
    v_add_f32_dpp v102, v102, v102 row_ror:1 row_mask:0xf bank_mask:0xf
    v_mul_f32 v100, 0xbfb8aa3b, v100
    v_mul_f32 v102, 0xbfb8aa3b, v102
    v_exp_f32 v100, v100
    v_exp_f32 v102, v102
    v_add_f32 v100, 1.0, v100
    v_add_f32 v102, 1.0, v102
    v_rcp_f32 v100, v100
    v_rcp_f32 v102, v102
    v_lshlrev_b32 v4, 3, v2
    s_lshl_b32 s32, s94, 3
    s_add_u32 s32, s32, 12148736
    buffer_store_dwordx2 v[100:101], v4, s[4:7], s32 offen offset:0 sc0 sc1
    buffer_store_dwordx2 v[102:103], v4, s[4:7], s32 offen offset:32 sc0 sc1
    s_nop 1
F_NOG:
    ds_read_b128 v[144:147], v11 offset:0
    s_waitcnt lgkmcnt(0)
    s_mov_b32 s89, 0
    s_nop 0
F_G6_L:
    v_min3_u32 v144, v144, v145, v146
    v_min_u32 v144, v144, v147
    v_cmp_gt_u32 vcc, 6, v144
    s_nop 3
    s_cbranch_vccz F_G6_D
    s_add_u32 s89, s89, 1
    s_cmp_ge_u32 s89, 320000
    s_cbranch_scc1 F_G6_D
    s_sleep 2
    ds_read_b128 v[144:147], v11 offset:0
    s_waitcnt lgkmcnt(0)
    s_branch F_G6_L
    s_nop 0
F_G6_D:
    v_mov_b32 v252, 0
    v_lshlrev_b32 v4, 9, v1
    s_mov_b64 exec, 31
    buffer_atomic_add v252, v4, s[4:7], s41 offen sc0 sc1
    s_mov_b64 exec, -1
    s_waitcnt vmcnt(0)
    v_cmp_gt_u32 vcc, 20, v252
    s_nop 0
    s_and_b64 vcc, vcc, 31
    s_mov_b32 s89, 0
    s_nop 1
F_FC2_L:
    s_cbranch_vccz F_FC2_D
    s_add_u32 s89, s89, 1
    s_cmp_ge_u32 s89, 40000
    s_cbranch_scc1 F_FC2_D
    s_sleep 8
    v_mov_b32 v252, 0
    v_lshlrev_b32 v4, 9, v1
    s_mov_b64 exec, 31
    buffer_atomic_add v252, v4, s[4:7], s41 offen sc0 sc1
    s_mov_b64 exec, -1
    s_waitcnt vmcnt(0)
    v_cmp_gt_u32 vcc, 20, v252
    s_nop 0
    s_and_b64 vcc, vcc, 31
    s_nop 1
    s_branch F_FC2_L
    s_nop 0
F_FC2_D:
    s_mul_i32 s73, s28, 204800
    s_mul_i32 s33, s42, 5120
    s_add_u32 s73, s73, s33
    s_add_u32 s73, s73, 10510336
    s_add_u32 s96, s73, 0
    buffer_load_dwordx4 v[160:163], v6, s[4:7], s96 offen offset:0 sc1
    buffer_load_dwordx4 v[164:167], v6, s[4:7], s96 offen offset:1024 sc1
    buffer_load_dwordx4 v[168:171], v6, s[4:7], s96 offen offset:2048 sc1
    buffer_load_dwordx4 v[172:175], v6, s[4:7], s96 offen offset:3072 sc1
    s_add_u32 s96, s96, 4096
    buffer_load_dwordx4 v[176:179], v6, s[4:7], s96 offen offset:0 sc1
    s_add_u32 s96, s73, 40960
    buffer_load_dwordx4 v[180:183], v6, s[4:7], s96 offen offset:0 sc1
    buffer_load_dwordx4 v[184:187], v6, s[4:7], s96 offen offset:1024 sc1
    buffer_load_dwordx4 v[188:191], v6, s[4:7], s96 offen offset:2048 sc1
    buffer_load_dwordx4 v[192:195], v6, s[4:7], s96 offen offset:3072 sc1
    s_add_u32 s96, s96, 4096
    buffer_load_dwordx4 v[196:199], v6, s[4:7], s96 offen offset:0 sc1
    s_add_u32 s96, s73, 81920
    buffer_load_dwordx4 v[200:203], v6, s[4:7], s96 offen offset:0 sc1
    buffer_load_dwordx4 v[204:207], v6, s[4:7], s96 offen offset:1024 sc1
    buffer_load_dwordx4 v[208:211], v6, s[4:7], s96 offen offset:2048 sc1
    buffer_load_dwordx4 v[212:215], v6, s[4:7], s96 offen offset:3072 sc1
    s_add_u32 s96, s96, 4096
    buffer_load_dwordx4 v[216:219], v6, s[4:7], s96 offen offset:0 sc1
    s_add_u32 s96, s73, 122880
    buffer_load_dwordx4 v[220:223], v6, s[4:7], s96 offen offset:0 sc1
    buffer_load_dwordx4 v[224:227], v6, s[4:7], s96 offen offset:1024 sc1
    buffer_load_dwordx4 v[228:231], v6, s[4:7], s96 offen offset:2048 sc1
    buffer_load_dwordx4 v[232:235], v6, s[4:7], s96 offen offset:3072 sc1
    s_add_u32 s96, s96, 4096
    buffer_load_dwordx4 v[236:239], v6, s[4:7], s96 offen offset:0 sc1
    s_add_u32 s96, s73, 163840
    buffer_load_dwordx4 v[16:19], v6, s[4:7], s96 offen offset:0 sc1
    buffer_load_dwordx4 v[20:23], v6, s[4:7], s96 offen offset:1024 sc1
    buffer_load_dwordx4 v[24:27], v6, s[4:7], s96 offen offset:2048 sc1
    buffer_load_dwordx4 v[28:31], v6, s[4:7], s96 offen offset:3072 sc1
    s_add_u32 s96, s96, 4096
    buffer_load_dwordx4 v[32:35], v6, s[4:7], s96 offen offset:0 sc1
    s_mov_b32 s94, 1073741824
    ds_read_b128 v[144:147], v11 offset:0
    s_waitcnt lgkmcnt(0)
    s_mov_b32 s89, 0
    s_nop 0
F_G8_L:
    v_min3_u32 v144, v144, v145, v146
    v_min_u32 v144, v144, v147
    v_cmp_gt_u32 vcc, 8, v144
    s_nop 3
    s_cbranch_vccz F_G8_D
    s_add_u32 s89, s89, 1
    s_cmp_ge_u32 s89, 320000
    s_cbranch_scc1 F_G8_D
    s_sleep 2
    ds_read_b128 v[144:147], v11 offset:0
    s_waitcnt lgkmcnt(0)
    s_branch F_G8_L
    s_nop 0
F_G8_D:
F_J:
    v_bfe_u32 v156, v1, 2, 2
    v_mul_u32_u24 v156, 10240, v156
    v_lshl_add_u32 v156, v2, 6, v156
    v_and_b32 v4, 3, v1
    v_lshl_add_u32 v156, v4, 4, v156
    s_mul_i32 s90, s27, 163840
    s_mul_i32 s33, s42, 1280
    s_add_u32 s90, s90, s33
    s_add_u32 s90, s90, 8192
    s_mul_i32 s33, s28, 86
    s_lshr_b32 s33, s33, 8
    s_mul_i32 s33, s33, 3
    s_sub_u32 s92, s28, s33
    s_add_u32 s33, s92, 0
    s_cmp_ge_u32 s33, 3
    s_cselect_b32 s34, 3, 0
    s_sub_u32 s33, s33, s34
    s_add_u32 s34, s33, s24
    s_add_u32 s34, s34, 1
    s_and_b32 s34, s34, 3
    s_mul_i32 s36, s34, 40960
    s_add_u32 s36, s36, s90
    s_sub_u32 s33, s42, s34
    s_sub_u32 s33, s33, 1
    s_and_b32 s33, s33, 7
    s_lshl_b32 s33, s33, 10
    s_mul_i32 s44, s34, 35840
    s_xor_b32 s45, s33, 4096
    s_add_u32 s45, s45, s44
    s_add_u32 s44, s44, s33
    s_add_u32 s33, s92, 1
    s_cmp_ge_u32 s33, 3
    s_cselect_b32 s34, 3, 0
    s_sub_u32 s33, s33, s34
    s_add_u32 s34, s33, s24
    s_add_u32 s34, s34, 1
    s_and_b32 s34, s34, 3
    s_mul_i32 s37, s34, 40960
    s_add_u32 s37, s37, s90
    s_sub_u32 s33, s42, s34
    s_sub_u32 s33, s33, 1
    s_and_b32 s33, s33, 7
    s_lshl_b32 s33, s33, 10
    s_mul_i32 s46, s34, 35840
    s_xor_b32 s47, s33, 4096
    s_add_u32 s47, s47, s46
    s_add_u32 s46, s46, s33
    s_add_u32 s33, s92, 2
    s_cmp_ge_u32 s33, 3
    s_cselect_b32 s34, 3, 0
    s_sub_u32 s33, s33, s34
    s_add_u32 s34, s33, s24
    s_add_u32 s34, s34, 1
    s_and_b32 s34, s34, 3
    s_mul_i32 s38, s34, 40960
    s_add_u32 s38, s38, s90
    s_sub_u32 s33, s42, s34
    s_sub_u32 s33, s33, 1
    s_and_b32 s33, s33, 7
    s_lshl_b32 s33, s33, 10
    s_mul_i32 s48, s34, 35840
    s_xor_b32 s49, s33, 4096
    s_add_u32 s49, s49, s48
    s_add_u32 s48, s48, s33
    s_mov_b32 s34, s24
    s_mul_i32 s39, s34, 40960
    s_add_u32 s39, s39, s90
    s_sub_u32 s33, s42, s34
    s_sub_u32 s33, s33, 1
    s_and_b32 s33, s33, 7
    s_lshl_b32 s33, s33, 10
    s_mul_i32 s50, s34, 35840
    s_xor_b32 s51, s33, 4096
    s_add_u32 s51, s51, s50
    s_add_u32 s50, s50, s33
    v_lshlrev_b32 v115, 2, v3
    s_lshl_b32 s33, s42, 2
    v_add_u32 v4, s33, v2
    s_mov_b32 s33, 81920
    v_mad_u32_u24 v0, v4, s33, v115
    v_lshlrev_b32 v111, 4, v2
    v_mad_u32_u24 v111, v3, s33, v111
    v_lshlrev_b32 v255, 8, v3
    s_lshr_b32 s54, s27, 3
    s_lshl_b32 s54, s54, 3
    s_add_u32 s54, s54, s42
    s_and_b32 s33, s28, 3
    s_lshl_b32 s54, s54, 2
    s_add_u32 s54, s54, s33
    s_lshl_b32 s54, s54, 7
    s_add_u32 s54, s54, 12337152
    s_lshl_b32 s55, s42, 2
    s_lshr_b32 s33, s28, 1
    s_add_u32 s55, s55, s33
    s_add_u32 s55, s55, 48
    s_lshr_b32 s33, s2, 6
    s_lshl_b32 s55, s55, 2
    s_add_u32 s55, s55, s33
    s_lshl_b32 s55, s55, 7
    s_add_u32 s55, s55, 12337152
    s_cmp_eq_u32 s42, 0
    s_cselect_b32 s56, 21, 20
    s_lshl_b32 s52, s27, 9
    s_lshl_b32 s33, s28, 6
    s_add_u32 s52, s52, s33
    s_add_u32 s52, s52, 7872512
    s_lshl_b32 s53, s24, 9
    s_add_u32 s53, s53, s27
    s_lshl_b32 s33, s24, 4
    v_add_u32 v4, s33, v3
    v_cvt_f32_u32 v4, v4
    v_mul_f32 v4, 0x3c800000, v4
    v_cvt_f32_u32 v5, v2
    v_mul_f32 v5, 4.0, v5
    v_mul_f32 v5, v5, v4
    v_fmamk_f32 v136, v4, 0x00000000, v5
    v_fmamk_f32 v137, v4, 0x3f800000, v5
    v_fmamk_f32 v138, v4, 0x40000000, v5
    v_fmamk_f32 v139, v4, 0x40400000, v5
    v_fmamk_f32 v140, v4, 0x41800000, v5
    v_fmamk_f32 v141, v4, 0x41880000, v5
    v_fmamk_f32 v142, v4, 0x41900000, v5
    v_fmamk_f32 v143, v4, 0x41980000, v5
    v_cos_f32 v144, v136
    v_cos_f32 v145, v137
    v_cos_f32 v146, v138
    v_cos_f32 v147, v139
    v_cos_f32 v148, v140
    v_cos_f32 v149, v141
    v_cos_f32 v150, v142
    v_cos_f32 v151, v143
    v_sin_f32 v136, v136
    v_sin_f32 v137, v137
    v_sin_f32 v138, v138
    v_sin_f32 v139, v139
    v_sin_f32 v140, v140
    v_sin_f32 v141, v141
    v_sin_f32 v142, v142
    v_sin_f32 v143, v143
    v_cvt_pk_bf16_f32 v96, v144, -v136
    v_cvt_pk_bf16_f32 v97, v145, -v137
    v_cvt_pk_bf16_f32 v98, v146, -v138
    v_cvt_pk_bf16_f32 v99, v147, -v139
    v_cvt_pk_bf16_f32 v100, v148, -v140
    v_cvt_pk_bf16_f32 v101, v149, -v141
    v_cvt_pk_bf16_f32 v102, v150, -v142
    v_cvt_pk_bf16_f32 v103, v151, -v143
    v_lshlrev_b32 v4, 31, v3
    v_or_b32 v4, 0x3f003f00, v4
    v_cmp_eq_u32 vcc, 0, v2
    s_nop 1
    v_cndmask_b32 v96, v96, v4, vcc
    v_add_u32 v5, s28, v3
    v_mul_u32_u24 v5, 3, v5
    v_mul_u32_u24 v136, 205, v5
    v_lshrrev_b32 v136, 10, v136
    v_mul_u32_u24 v136, 5, v136
    v_sub_u32 v5, v5, v136
    v_mul_u32_u24 v104, 2304, v5
    v_add_u32 v105, 4608, v104
    v_subrev_u32 v136, 11520, v105
    v_min_u32 v105, v105, v136
    v_add_u32 v106, 4608, v105
    v_subrev_u32 v136, 11520, v106
    v_min_u32 v106, v106, v136
    v_add_u32 v107, 4608, v106
    v_subrev_u32 v136, 11520, v107
    v_min_u32 v107, v107, v136
    v_add_u32 v108, 4608, v107
    v_subrev_u32 v136, 11520, v108
    v_min_u32 v108, v108, v136
    v_mul_u32_u24 v4, 144, v3
    v_lshl_add_u32 v5, v2, 2, v4
    s_lshl_b32 s33, s42, 4
    s_add_u32 s33, s33, 143360
    v_add_u32 v5, s33, v5
    v_add_u32 v104, v104, v5
    v_add_u32 v105, v105, v5
    v_add_u32 v106, v106, v5
    v_add_u32 v107, v107, v5
    v_add_u32 v108, v108, v5
    v_lshl_add_u32 v109, v2, 4, v4
    v_add_u32 v109, 143360, v109
    s_mul_i32 s33, s24, 35840
    v_add_u32 v110, s33, v6
    s_mov_b32 s8, s62
    s_mov_b32 s9, s63
    s_mov_b32 s10, 5242880
    s_mov_b32 s11, 0x20000
    s_waitcnt vmcnt(10)
    s_setprio 3
    v_mov_b32 v157, 1
    v_lshlrev_b32 v158, 7, v1
    s_mov_b64 exec, 15
    buffer_atomic_add v157, v158, s[4:7], s94 offen sc1
    s_mov_b64 exec, -1
    s_setprio 0
    s_cmp_gt_u32 s2, 160
    s_cbranch_scc1 F_NCF
    s_add_u32 s96, s73, 81920
    buffer_load_dwordx4 v[200:203], v6, s[4:7], s96 offen offset:0 sc1
    buffer_load_dwordx4 v[204:207], v6, s[4:7], s96 offen offset:1024 sc1
    buffer_load_dwordx4 v[208:211], v6, s[4:7], s96 offen offset:2048 sc1
    buffer_load_dwordx4 v[212:215], v6, s[4:7], s96 offen offset:3072 sc1
    s_add_u32 s96, s96, 4096
    buffer_load_dwordx4 v[216:219], v6, s[4:7], s96 offen offset:0 sc1
    s_add_u32 s96, s73, 122880
    buffer_load_dwordx4 v[220:223], v6, s[4:7], s96 offen offset:0 sc1
    buffer_load_dwordx4 v[224:227], v6, s[4:7], s96 offen offset:1024 sc1
    buffer_load_dwordx4 v[228:231], v6, s[4:7], s96 offen offset:2048 sc1
    buffer_load_dwordx4 v[232:235], v6, s[4:7], s96 offen offset:3072 sc1
    s_add_u32 s96, s96, 4096
    buffer_load_dwordx4 v[236:239], v6, s[4:7], s96 offen offset:0 sc1
    s_add_u32 s96, s73, 163840
    buffer_load_dwordx4 v[16:19], v6, s[4:7], s96 offen offset:0 sc1
    buffer_load_dwordx4 v[20:23], v6, s[4:7], s96 offen offset:1024 sc1
    buffer_load_dwordx4 v[24:27], v6, s[4:7], s96 offen offset:2048 sc1
    buffer_load_dwordx4 v[28:31], v6, s[4:7], s96 offen offset:3072 sc1
    s_add_u32 s96, s96, 4096
    buffer_load_dwordx4 v[32:35], v6, s[4:7], s96 offen offset:0 sc1
    s_nop 1
F_NCF:
    v_mov_b32 v252, 0
    s_mov_b64 exec, 1
    buffer_atomic_add v252, v10, s[4:7], s54 offen sc0 sc1
    s_mov_b64 exec, -1
    s_waitcnt vmcnt(0)
    v_cmp_gt_u32 vcc, 32, v252
    s_nop 0
    s_and_b64 vcc, vcc, 1
    s_mov_b32 s89, 0
    s_nop 1
F_FH_L:
    s_cbranch_vccz F_FH_D
    s_add_u32 s89, s89, 1
    s_cmp_ge_u32 s89, 40000
    s_cbranch_scc1 F_FH_D
    s_sleep 4
    v_mov_b32 v252, 0
    s_mov_b64 exec, 1
    buffer_atomic_add v252, v10, s[4:7], s54 offen sc0 sc1
    s_mov_b64 exec, -1
    s_waitcnt vmcnt(0)
    v_cmp_gt_u32 vcc, 32, v252
    s_nop 0
    s_and_b64 vcc, vcc, 1
    s_nop 1
    s_branch F_FH_L
    s_nop 0
F_FH_D:
    buffer_load_dwordx4 v[36:39], v156, s[4:7], s36 offen offset:0 sc1
    buffer_load_dwordx4 v[40:43], v156, s[4:7], s36 offen offset:256 sc1
    buffer_load_dwordx4 v[44:47], v156, s[4:7], s36 offen offset:512 sc1
    buffer_load_dwordx4 v[48:51], v156, s[4:7], s36 offen offset:768 sc1
    buffer_load_dwordx4 v[52:55], v156, s[4:7], s36 offen offset:1024 sc1
    buffer_load_dwordx4 v[56:59], v156, s[4:7], s37 offen offset:0 sc1
    buffer_load_dwordx4 v[60:63], v156, s[4:7], s37 offen offset:256 sc1
    buffer_load_dwordx4 v[64:67], v156, s[4:7], s37 offen offset:512 sc1
    buffer_load_dwordx4 v[68:71], v156, s[4:7], s37 offen offset:768 sc1
    buffer_load_dwordx4 v[72:75], v156, s[4:7], s37 offen offset:1024 sc1
    s_waitcnt lgkmcnt(0)
    s_waitcnt vmcnt(9)
    v_mfma_f32_16x16x32_bf16 v[116:119], v[160:163], v[36:39], 0
    v_mfma_f32_16x16x32_bf16 v[120:123], v[180:183], v[36:39], 0
    v_mfma_f32_16x16x32_bf16 v[124:127], v[200:203], v[36:39], 0
    buffer_load_dwordx4 v[76:79], v156, s[4:7], s38 offen offset:0 sc1
    v_mfma_f32_16x16x32_bf16 v[128:131], v[220:223], v[36:39], 0
    v_mfma_f32_16x16x32_bf16 v[132:135], v[16:19], v[36:39], 0
    s_waitcnt vmcnt(9)
    v_mfma_f32_16x16x32_bf16 v[116:119], v[164:167], v[40:43], v[116:119]
    v_mfma_f32_16x16x32_bf16 v[120:123], v[184:187], v[40:43], v[120:123]
    v_mfma_f32_16x16x32_bf16 v[124:127], v[204:207], v[40:43], v[124:127]
    buffer_load_dwordx4 v[80:83], v156, s[4:7], s38 offen offset:256 sc1
    v_mfma_f32_16x16x32_bf16 v[128:131], v[224:227], v[40:43], v[128:131]
    v_mfma_f32_16x16x32_bf16 v[132:135], v[20:23], v[40:43], v[132:135]
    s_waitcnt vmcnt(9)
    v_mfma_f32_16x16x32_bf16 v[116:119], v[168:171], v[44:47], v[116:119]
    v_mfma_f32_16x16x32_bf16 v[120:123], v[188:191], v[44:47], v[120:123]
    v_mfma_f32_16x16x32_bf16 v[124:127], v[208:211], v[44:47], v[124:127]
    buffer_load_dwordx4 v[84:87], v156, s[4:7], s38 offen offset:512 sc1
    v_mfma_f32_16x16x32_bf16 v[128:131], v[228:231], v[44:47], v[128:131]
    v_mfma_f32_16x16x32_bf16 v[132:135], v[24:27], v[44:47], v[132:135]
    s_waitcnt vmcnt(9)
    v_mfma_f32_16x16x32_bf16 v[116:119], v[172:175], v[48:51], v[116:119]
    v_mfma_f32_16x16x32_bf16 v[120:123], v[192:195], v[48:51], v[120:123]
    v_mfma_f32_16x16x32_bf16 v[124:127], v[212:215], v[48:51], v[124:127]
    buffer_load_dwordx4 v[88:91], v156, s[4:7], s38 offen offset:768 sc1
    v_mfma_f32_16x16x32_bf16 v[128:131], v[232:235], v[48:51], v[128:131]
    v_mfma_f32_16x16x32_bf16 v[132:135], v[28:31], v[48:51], v[132:135]
    s_waitcnt vmcnt(9)
    v_mfma_f32_16x16x32_bf16 v[116:119], v[176:179], v[52:55], v[116:119]
    v_mfma_f32_16x16x32_bf16 v[120:123], v[196:199], v[52:55], v[120:123]
    v_mfma_f32_16x16x32_bf16 v[124:127], v[216:219], v[52:55], v[124:127]
    buffer_load_dwordx4 v[92:95], v156, s[4:7], s38 offen offset:1024 sc1
    v_mfma_f32_16x16x32_bf16 v[128:131], v[236:239], v[52:55], v[128:131]
    v_mfma_f32_16x16x32_bf16 v[132:135], v[32:35], v[52:55], v[132:135]
    v_mov_b32 v252, 0
    s_mov_b64 exec, 1
    buffer_atomic_add v252, v10, s[4:7], s55 offen sc0 sc1
    s_mov_b64 exec, -1
    buffer_load_dwordx4 v[36:39], v156, s[4:7], s39 offen offset:0 sc1
    buffer_load_dwordx4 v[40:43], v156, s[4:7], s39 offen offset:256 sc1
    buffer_load_dwordx4 v[44:47], v156, s[4:7], s39 offen offset:512 sc1
    buffer_load_dwordx4 v[48:51], v156, s[4:7], s39 offen offset:768 sc1
    buffer_load_dwordx4 v[52:55], v156, s[4:7], s39 offen offset:1024 sc1
    v_add_u32 v158, s44, v6
    v_add_u32 v159, s45, v6
    s_barrier
    s_waitcnt vmcnt(15)
    v_mfma_f32_16x16x32_bf16 v[136:139], v[160:163], v[56:59], 0
    v_mfma_f32_16x16x32_bf16 v[140:143], v[180:183], v[56:59], 0
    v_mfma_f32_16x16x32_bf16 v[144:147], v[200:203], v[56:59], 0
    ds_write_b128 v158, v[116:119] offset:0
    v_mfma_f32_16x16x32_bf16 v[148:151], v[220:223], v[56:59], 0
    v_mfma_f32_16x16x32_bf16 v[152:155], v[16:19], v[56:59], 0
    s_waitcnt vmcnt(14)
    v_mfma_f32_16x16x32_bf16 v[136:139], v[164:167], v[60:63], v[136:139]
    v_mfma_f32_16x16x32_bf16 v[140:143], v[184:187], v[60:63], v[140:143]
    v_mfma_f32_16x16x32_bf16 v[144:147], v[204:207], v[60:63], v[144:147]
    ds_write_b128 v158, v[120:123] offset:7168
    v_mfma_f32_16x16x32_bf16 v[148:151], v[224:227], v[60:63], v[148:151]
    v_mfma_f32_16x16x32_bf16 v[152:155], v[20:23], v[60:63], v[152:155]
    s_waitcnt vmcnt(13)
    v_mfma_f32_16x16x32_bf16 v[136:139], v[168:171], v[64:67], v[136:139]
    v_mfma_f32_16x16x32_bf16 v[140:143], v[188:191], v[64:67], v[140:143]
    v_mfma_f32_16x16x32_bf16 v[144:147], v[208:211], v[64:67], v[144:147]
    ds_write_b128 v158, v[124:127] offset:14336
    v_mfma_f32_16x16x32_bf16 v[148:151], v[228:231], v[64:67], v[148:151]
    v_mfma_f32_16x16x32_bf16 v[152:155], v[24:27], v[64:67], v[152:155]
    s_waitcnt vmcnt(12)
    v_mfma_f32_16x16x32_bf16 v[136:139], v[172:175], v[68:71], v[136:139]
    v_mfma_f32_16x16x32_bf16 v[140:143], v[192:195], v[68:71], v[140:143]
    v_mfma_f32_16x16x32_bf16 v[144:147], v[212:215], v[68:71], v[144:147]
    ds_write_b128 v159, v[128:131] offset:21504
    v_mfma_f32_16x16x32_bf16 v[148:151], v[232:235], v[68:71], v[148:151]
    v_mfma_f32_16x16x32_bf16 v[152:155], v[28:31], v[68:71], v[152:155]
    s_waitcnt vmcnt(11)
    v_mfma_f32_16x16x32_bf16 v[136:139], v[176:179], v[72:75], v[136:139]
    v_mfma_f32_16x16x32_bf16 v[140:143], v[196:199], v[72:75], v[140:143]
    v_mfma_f32_16x16x32_bf16 v[144:147], v[216:219], v[72:75], v[144:147]
    ds_write_b128 v159, v[132:135] offset:28672
    v_mfma_f32_16x16x32_bf16 v[148:151], v[236:239], v[72:75], v[148:151]
    v_mfma_f32_16x16x32_bf16 v[152:155], v[32:35], v[72:75], v[152:155]
    v_add_u32 v158, s46, v6
    v_add_u32 v159, s47, v6
    s_waitcnt vmcnt(10)
    v_mfma_f32_16x16x32_bf16 v[116:119], v[160:163], v[76:79], 0
    v_mfma_f32_16x16x32_bf16 v[120:123], v[180:183], v[76:79], 0
    v_mfma_f32_16x16x32_bf16 v[124:127], v[200:203], v[76:79], 0
    ds_write_b128 v158, v[136:139] offset:0
    v_mfma_f32_16x16x32_bf16 v[128:131], v[220:223], v[76:79], 0
    v_mfma_f32_16x16x32_bf16 v[132:135], v[16:19], v[76:79], 0
    s_waitcnt vmcnt(9)
    v_mfma_f32_16x16x32_bf16 v[116:119], v[164:167], v[80:83], v[116:119]
    v_mfma_f32_16x16x32_bf16 v[120:123], v[184:187], v[80:83], v[120:123]
    v_mfma_f32_16x16x32_bf16 v[124:127], v[204:207], v[80:83], v[124:127]
    ds_write_b128 v158, v[140:143] offset:7168
    v_mfma_f32_16x16x32_bf16 v[128:131], v[224:227], v[80:83], v[128:131]
    v_mfma_f32_16x16x32_bf16 v[132:135], v[20:23], v[80:83], v[132:135]
    s_waitcnt vmcnt(8)
    v_mfma_f32_16x16x32_bf16 v[116:119], v[168:171], v[84:87], v[116:119]
    v_mfma_f32_16x16x32_bf16 v[120:123], v[188:191], v[84:87], v[120:123]
    v_mfma_f32_16x16x32_bf16 v[124:127], v[208:211], v[84:87], v[124:127]
    ds_write_b128 v158, v[144:147] offset:14336
    v_mfma_f32_16x16x32_bf16 v[128:131], v[228:231], v[84:87], v[128:131]
    v_mfma_f32_16x16x32_bf16 v[132:135], v[24:27], v[84:87], v[132:135]
    s_waitcnt vmcnt(7)
    v_mfma_f32_16x16x32_bf16 v[116:119], v[172:175], v[88:91], v[116:119]
    v_mfma_f32_16x16x32_bf16 v[120:123], v[192:195], v[88:91], v[120:123]
    v_mfma_f32_16x16x32_bf16 v[124:127], v[212:215], v[88:91], v[124:127]
    ds_write_b128 v159, v[148:151] offset:21504
    v_mfma_f32_16x16x32_bf16 v[128:131], v[232:235], v[88:91], v[128:131]
    v_mfma_f32_16x16x32_bf16 v[132:135], v[28:31], v[88:91], v[132:135]
    s_waitcnt vmcnt(6)
    v_mfma_f32_16x16x32_bf16 v[116:119], v[176:179], v[92:95], v[116:119]
    v_mfma_f32_16x16x32_bf16 v[120:123], v[196:199], v[92:95], v[120:123]
    v_mfma_f32_16x16x32_bf16 v[124:127], v[216:219], v[92:95], v[124:127]
    ds_write_b128 v159, v[152:155] offset:28672
    v_mfma_f32_16x16x32_bf16 v[128:131], v[236:239], v[92:95], v[128:131]
    v_mfma_f32_16x16x32_bf16 v[132:135], v[32:35], v[92:95], v[132:135]
    s_waitcnt vmcnt(5)
    v_cmp_gt_u32 vcc, s56, v252
    s_nop 0
    s_and_b64 vcc, vcc, 1
    s_mov_b32 s89, 0
    s_nop 2
F_FP_L:
    s_cbranch_vccz F_FP_D
    s_add_u32 s89, s89, 1
    s_cmp_ge_u32 s89, 40000
    s_cbranch_scc1 F_FP_D
    s_sleep 2
    v_mov_b32 v252, 0
    s_mov_b64 exec, 1
    buffer_atomic_add v252, v10, s[4:7], s55 offen sc0 sc1
    s_mov_b64 exec, -1
    s_waitcnt vmcnt(0)
    v_cmp_gt_u32 vcc, s56, v252
    s_nop 0
    s_and_b64 vcc, vcc, 1
    s_nop 1
    s_branch F_FP_L
    s_nop 0
F_FP_D:
    s_add_u32 s32, s52, 0
    buffer_load_dword v12, v0, s[4:7], s32 offen sc1
    s_add_u32 s32, s52, 16384
    buffer_load_dword v13, v0, s[4:7], s32 offen sc1
    s_add_u32 s32, s52, 32768
    buffer_load_dword v7, v0, s[4:7], s32 offen sc1
    s_add_u32 s32, s52, 49152
    buffer_load_dword v8, v0, s[4:7], s32 offen sc1
    s_add_u32 s32, s52, 65536
    buffer_load_dword v9, v0, s[4:7], s32 offen sc1
    s_lshl_b32 s32, s53, 3
    s_add_u32 s32, s32, 12148736
    buffer_load_dwordx2 v[14:15], v255, s[4:7], s32 offen sc1
    v_add_u32 v158, s48, v6
    v_add_u32 v159, s49, v6
    ds_write_b128 v158, v[116:119] offset:0
    ds_write_b128 v158, v[120:123] offset:7168
    ds_write_b128 v158, v[124:127] offset:14336
    ds_write_b128 v159, v[128:131] offset:21504
    ds_write_b128 v159, v[132:135] offset:28672
    v_lshlrev_b32 v136, 16, v240
    v_and_b32 v137, 0xffff0000, v240
    v_lshlrev_b32 v138, 16, v246
    v_and_b32 v139, 0xffff0000, v246
    v_pk_mul_f32 v[84:85], v[136:137], v[138:139]
    v_lshlrev_b32 v136, 16, v241
    v_and_b32 v137, 0xffff0000, v241
    v_lshlrev_b32 v138, 16, v247
    v_and_b32 v139, 0xffff0000, v247
    v_pk_mul_f32 v[86:87], v[136:137], v[138:139]
    v_lshlrev_b32 v136, 16, v242
    v_and_b32 v137, 0xffff0000, v242
    v_lshlrev_b32 v138, 16, v248
    v_and_b32 v139, 0xffff0000, v248
    v_pk_mul_f32 v[88:89], v[136:137], v[138:139]
    v_lshlrev_b32 v136, 16, v243
    v_and_b32 v137, 0xffff0000, v243
    v_lshlrev_b32 v138, 16, v249
    v_and_b32 v139, 0xffff0000, v249
    v_pk_mul_f32 v[90:91], v[136:137], v[138:139]
    v_add_u32 v158, s50, v6
    v_add_u32 v159, s51, v6
    s_waitcnt lgkmcnt(0)
    s_barrier
    ds_read_b128 v[56:59], v110 offset:21504
    ds_read_b128 v[60:63], v110 offset:22528
    ds_read_b128 v[64:67], v110 offset:23552
    ds_read_b128 v[68:71], v110 offset:25600
    ds_read_b128 v[72:75], v110 offset:26624
    ds_read_b128 v[76:79], v110 offset:27648
    ds_read_b128 v[116:119], v110 offset:28672
    ds_read_b128 v[120:123], v110 offset:29696
    ds_read_b128 v[124:127], v110 offset:30720
    ds_read_b128 v[128:131], v110 offset:32768
    ds_read_b128 v[132:135], v110 offset:33792
    ds_read_b128 v[136:139], v110 offset:34816
    s_waitcnt lgkmcnt(6)
    v_pk_add_f32 v[56:57], v[56:57], v[60:61]
    v_pk_add_f32 v[64:65], v[64:65], v[68:69]
    v_pk_add_f32 v[72:73], v[72:73], v[76:77]
    v_pk_add_f32 v[58:59], v[58:59], v[62:63]
    v_pk_add_f32 v[66:67], v[66:67], v[70:71]
    v_pk_add_f32 v[74:75], v[74:75], v[78:79]
    v_pk_add_f32 v[56:57], v[56:57], v[64:65]
    v_pk_add_f32 v[84:85], v[84:85], v[72:73]
    v_pk_add_f32 v[58:59], v[58:59], v[66:67]
    v_pk_add_f32 v[86:87], v[86:87], v[74:75]
    v_pk_add_f32 v[84:85], v[84:85], v[56:57]
    v_pk_add_f32 v[86:87], v[86:87], v[58:59]
    s_waitcnt lgkmcnt(0)
    v_pk_add_f32 v[116:117], v[116:117], v[120:121]
    v_pk_add_f32 v[124:125], v[124:125], v[128:129]
    v_pk_add_f32 v[132:133], v[132:133], v[136:137]
    v_pk_add_f32 v[118:119], v[118:119], v[122:123]
    v_pk_add_f32 v[126:127], v[126:127], v[130:131]
    v_pk_add_f32 v[134:135], v[134:135], v[138:139]
    v_pk_add_f32 v[116:117], v[116:117], v[124:125]
    v_pk_add_f32 v[88:89], v[88:89], v[132:133]
    v_pk_add_f32 v[118:119], v[118:119], v[126:127]
    v_pk_add_f32 v[90:91], v[90:91], v[134:135]
    v_pk_add_f32 v[88:89], v[88:89], v[116:117]
    v_pk_add_f32 v[90:91], v[90:91], v[118:119]
    s_waitcnt vmcnt(10)
    v_mfma_f32_16x16x32_bf16 v[136:139], v[160:163], v[36:39], 0
    v_mfma_f32_16x16x32_bf16 v[140:143], v[180:183], v[36:39], 0
    v_mfma_f32_16x16x32_bf16 v[144:147], v[200:203], v[36:39], 0
    v_mfma_f32_16x16x32_bf16 v[148:151], v[220:223], v[36:39], v[84:87]
    v_mfma_f32_16x16x32_bf16 v[152:155], v[16:19], v[36:39], v[88:91]
    s_waitcnt vmcnt(9)
    v_mfma_f32_16x16x32_bf16 v[136:139], v[164:167], v[40:43], v[136:139]
    v_mfma_f32_16x16x32_bf16 v[140:143], v[184:187], v[40:43], v[140:143]
    v_mfma_f32_16x16x32_bf16 v[144:147], v[204:207], v[40:43], v[144:147]
    v_mfma_f32_16x16x32_bf16 v[148:151], v[224:227], v[40:43], v[148:151]
    v_mfma_f32_16x16x32_bf16 v[152:155], v[20:23], v[40:43], v[152:155]
    s_waitcnt vmcnt(8)
    v_mfma_f32_16x16x32_bf16 v[136:139], v[168:171], v[44:47], v[136:139]
    v_mfma_f32_16x16x32_bf16 v[140:143], v[188:191], v[44:47], v[140:143]
    v_mfma_f32_16x16x32_bf16 v[144:147], v[208:211], v[44:47], v[144:147]
    v_mfma_f32_16x16x32_bf16 v[148:151], v[228:231], v[44:47], v[148:151]
    v_mfma_f32_16x16x32_bf16 v[152:155], v[24:27], v[44:47], v[152:155]
    s_waitcnt vmcnt(7)
    v_mfma_f32_16x16x32_bf16 v[136:139], v[172:175], v[48:51], v[136:139]
    v_mfma_f32_16x16x32_bf16 v[140:143], v[192:195], v[48:51], v[140:143]
    v_mfma_f32_16x16x32_bf16 v[144:147], v[212:215], v[48:51], v[144:147]
    v_mfma_f32_16x16x32_bf16 v[148:151], v[232:235], v[48:51], v[148:151]
    v_mfma_f32_16x16x32_bf16 v[152:155], v[28:31], v[48:51], v[152:155]
    s_waitcnt vmcnt(6)
    v_mfma_f32_16x16x32_bf16 v[136:139], v[176:179], v[52:55], v[136:139]
    v_mfma_f32_16x16x32_bf16 v[140:143], v[196:199], v[52:55], v[140:143]
    v_mfma_f32_16x16x32_bf16 v[144:147], v[216:219], v[52:55], v[144:147]
    v_mfma_f32_16x16x32_bf16 v[148:151], v[236:239], v[52:55], v[148:151]
    v_mfma_f32_16x16x32_bf16 v[152:155], v[32:35], v[52:55], v[152:155]
    s_waitcnt vmcnt(0)
    s_nop 2
    ds_write_b128 v158, v[136:139] offset:0
    ds_write_b128 v158, v[140:143] offset:7168
    ds_write_b128 v158, v[144:147] offset:14336
    v_lshlrev_b32 v56, 16, v12
    v_and_b32 v57, 0xffff0000, v12
    v_lshlrev_b32 v58, 16, v13
    v_and_b32 v59, 0xffff0000, v13
    v_lshlrev_b32 v60, 16, v7
    v_and_b32 v61, 0xffff0000, v7
    v_lshlrev_b32 v62, 16, v8
    v_and_b32 v63, 0xffff0000, v8
    v_lshlrev_b32 v64, 16, v9
    v_and_b32 v65, 0xffff0000, v9
    v_pk_add_f32 v[66:67], v[58:59], v[64:65]
    v_pk_add_f32 v[68:69], v[58:59], v[64:65] neg_lo:[0,1] neg_hi:[0,1]
    v_pk_add_f32 v[70:71], v[60:61], v[62:63]
    v_pk_add_f32 v[72:73], v[60:61], v[62:63] neg_lo:[0,1] neg_hi:[0,1]
    v_pk_add_f32 v[82:83], v[56:57], v[66:67]
    v_pk_fma_f32 v[74:75], v[66:67], s[78:79], v[56:57]
    v_pk_fma_f32 v[76:77], v[66:67], s[80:81], v[56:57]
    v_pk_mul_f32 v[78:79], v[68:69], s[82:83]
    v_pk_mul_f32 v[80:81], v[68:69], s[84:85]
    v_pk_add_f32 v[82:83], v[82:83], v[70:71]
    v_pk_fma_f32 v[74:75], v[70:71], s[80:81], v[74:75]
    v_pk_fma_f32 v[76:77], v[70:71], s[78:79], v[76:77]
    v_pk_fma_f32 v[78:79], v[72:73], s[84:85], v[78:79]
    v_pk_fma_f32 v[80:81], v[72:73], s[82:83], v[80:81] neg_lo:[1,0,0] neg_hi:[1,0,0]
    v_sub_f32 v66, v74, v79
    v_add_f32 v67, v75, v78
    v_add_f32 v68, v74, v79
    v_sub_f32 v69, v75, v78
    v_sub_f32 v70, v76, v81
    v_add_f32 v71, v77, v80
    v_add_f32 v72, v76, v81
    v_sub_f32 v73, v77, v80
    v_cvt_pk_bf16_f32 v56, v82, v83
    ds_write_b32 v104, v56
    v_cvt_pk_bf16_f32 v58, v66, v67
    ds_write_b32 v105, v58
    v_cvt_pk_bf16_f32 v60, v70, v71
    ds_write_b32 v106, v60
    v_cvt_pk_bf16_f32 v62, v72, v73
    ds_write_b32 v107, v62
    v_cvt_pk_bf16_f32 v64, v68, v69
    ds_write_b32 v108, v64
    v_cmp_ne_u32 vcc, s43, v15
    s_mov_b32 s89, 0
    s_nop 3
F_GT_L:
    s_cbranch_vccz F_GT_D
    s_add_u32 s89, s89, 1
    s_cmp_ge_u32 s89, 40000
    s_cbranch_scc1 F_GT_D
    s_sleep 2
    s_lshl_b32 s32, s53, 3
    s_add_u32 s32, s32, 12148736
    buffer_load_dwordx2 v[14:15], v255, s[4:7], s32 offen sc1
    s_waitcnt vmcnt(0)
    v_cmp_ne_u32 vcc, s43, v15
    s_nop 3
    s_branch F_GT_L
    s_nop 0
F_GT_D:
    v_mul_f32 v112, 0x35cccccd, v14
    v_sub_f32 v114, 1.0, v14
    s_mul_i32 s32, s53, 2560
    s_lshl_b32 s33, s28, 6
    s_add_u32 s32, s32, s33
    s_waitcnt lgkmcnt(0)
    s_barrier
    ds_read_b128 v[56:59], v109 offset:6912
    ds_read_b128 v[60:63], v109 offset:6976
    ds_read_b128 v[64:67], v109 offset:9216
    ds_read_b128 v[68:71], v109 offset:9280
    ds_read_b128 v[116:119], v110 offset:24576
    ds_read_b128 v[120:123], v110 offset:31744
    s_waitcnt lgkmcnt(2)
    v_mfma_f32_16x16x32_bf16 v[240:243], v[56:59], v[96:99], 0
    v_mfma_f32_16x16x32_bf16 v[244:247], v[64:67], v[96:99], 0
    v_mfma_f32_16x16x32_bf16 v[240:243], v[60:63], v[100:103], v[240:243]
    v_mfma_f32_16x16x32_bf16 v[244:247], v[68:71], v[100:103], v[244:247]
    s_nop 6
    v_pk_mul_f32 v[240:241], v[240:241], v[112:113] op_sel_hi:[1,0]
    v_pk_mul_f32 v[242:243], v[242:243], v[112:113] op_sel_hi:[1,0]
    v_pk_mul_f32 v[244:245], v[244:245], v[112:113] op_sel_hi:[1,0]
    v_pk_mul_f32 v[246:247], v[246:247], v[112:113] op_sel_hi:[1,0]
    s_waitcnt lgkmcnt(1)
    v_pk_add_f32 v[148:149], v[148:149], v[116:117]
    v_pk_add_f32 v[150:151], v[150:151], v[118:119]
    v_pk_fma_f32 v[148:149], v[148:149], v[114:115], v[240:241] op_sel_hi:[1,0,1]
    v_pk_fma_f32 v[150:151], v[150:151], v[114:115], v[242:243] op_sel_hi:[1,0,1]
    buffer_store_dwordx4 v[148:151], v111, s[8:11], s32 offen offset:1536
    s_waitcnt lgkmcnt(0)
    v_pk_add_f32 v[152:153], v[152:153], v[120:121]
    v_pk_add_f32 v[154:155], v[154:155], v[122:123]
    v_pk_fma_f32 v[152:153], v[152:153], v[114:115], v[244:245] op_sel_hi:[1,0,1]
    v_pk_fma_f32 v[154:155], v[154:155], v[114:115], v[246:247] op_sel_hi:[1,0,1]
    buffer_store_dwordx4 v[152:155], v111, s[8:11], s32 offen offset:2048
    s_endpgm
    s_nop 2
W_END:
    s_endpgm
.section .rodata,"a"
.p2align 6
.amdhsa_kernel gated_mix__spectral_gfnet__ssm_conv_s5__prompt_kernel
  .amdhsa_next_free_vgpr 256
  .amdhsa_next_free_sgpr 97
  .amdhsa_accum_offset 256
  .amdhsa_group_segment_fixed_size 0
  .amdhsa_kernarg_size 128
  .amdhsa_user_sgpr_count 2
  .amdhsa_user_sgpr_kernarg_segment_ptr 1
  .amdhsa_system_sgpr_workgroup_id_x 1
  .amdhsa_float_denorm_mode_32 3
.end_amdhsa_kernel
```
